```python
import torch

def _softmax(x, axis=-1):
    return torch.softmax(x, dim=axis)
def _gelu(x):
    return torch.nn.functional.gelu(x, approximate="tanh")
def _silu(x):
    return torch.nn.functional.silu(x)
def _sigmoid(x):
    return torch.sigmoid(x)
def _layernorm(x, axis=-1, eps=1e-5):
    m = x.mean(dim=axis, keepdim=True)
    v = x.var(dim=axis, keepdim=True, unbiased=False)
    return (x - m) / torch.sqrt(v + eps)
def _scatter_add(tgt, idx, src, axis=0):
    return tgt.clone().index_add_(axis, idx, src)
def _segment_sum(src, seg, n):
    out = torch.zeros((n,) + src.shape[1:], dtype=src.dtype)
    return out.index_add_(0, seg, src)
def _pad(x, pw):
    flat = tuple(v for pair in reversed(pw) for v in pair)
    return torch.nn.functional.pad(x, flat)

kernel_name = 'gated_mix__linear_kernel_hedgehog__glu_gated_glu__prompt'

def setup_inputs():

    _w = (lambda a: (lambda t: t.to(torch.bfloat16) if t.is_floating_point() else t)(torch.as_tensor(a)))
    def _A_setup():
        B, S, D, H = 1, 2048, 1024, 32
        Dh = D // H
        return {
            "x": _w((lambda *s: torch.randn(*s, dtype=torch.bfloat16) * 0.05)(B, S, D)),
            "wqkv": _w((lambda *s: torch.randn(*s, dtype=torch.bfloat16) * 0.8)(D, 3 * D)),
            "w_phi": _w((lambda *s: torch.randn(*s, dtype=torch.bfloat16) * 0.8)(H, Dh, Dh) * (Dh ** -0.5)),
            "wo": _w((lambda *s: torch.randn(*s, dtype=torch.bfloat16) * 0.1)(D, D)),
        }
    _A_in = _A_setup()

    def _B_setup():
        B, S, D, F = 1, 2048, 1024, 3584
        return {
            "x": _w((lambda *s: torch.randn(*s, dtype=torch.bfloat16) * 0.05)(B, S, D)),
            "w_gate": _w((lambda *s: torch.randn(*s, dtype=torch.bfloat16) * 0.2)(D, F)),
            "w_up": _w((lambda *s: torch.randn(*s, dtype=torch.bfloat16) * 0.05)(D, F)),
            "w_down": _w((lambda *s: torch.randn(*s, dtype=torch.bfloat16) * 0.05)(F, D)),
        }
    _B_in = _B_setup()

    return {
        "A_x": _A_in["x"],
        "A_wqkv": _A_in["wqkv"],
        "A_w_phi": _A_in["w_phi"],
        "A_wo": _A_in["wo"],
        "B_x": _B_in["x"],
        "B_w_gate": _B_in["w_gate"],
        "B_w_up": _B_in["w_up"],
        "B_w_down": _B_in["w_down"],
        "gate_w": _w((lambda *s: torch.randn(*s, dtype=torch.bfloat16) * 0.05)(1024) * 16.0),
    }

def reference(A_x, A_wqkv, A_w_phi, A_wo, B_x, B_w_gate, B_w_up, B_w_down, gate_w):
    def _A_ref(x, wqkv, w_phi, wo):
        B, S, D = x.shape
        H = 32; Dh = D // H
        qkv = (lambda x, *d: x.permute(*d))((x @ wqkv).reshape(B, S, 3, H, Dh), 2, 0, 3, 1, 4)
        q, k, v = qkv[0], qkv[1], qkv[2]
        pq = torch.einsum("bhsd,hdf->bhsf", q, w_phi)
        pk = torch.einsum("bhsd,hdf->bhsf", k, w_phi)
        phi_q = torch.concatenate([_softmax(pq, axis=-1), _softmax(-pq, axis=-1)], axis=-1)
        phi_k = torch.concatenate([_softmax(pk, axis=-1), _softmax(-pk, axis=-1)], axis=-1)
        kv = torch.einsum("bhsf,bhsd->bhfd", phi_k, v)
        z  = torch.einsum("bhsf->bhf", phi_k)
        num = torch.einsum("bhqf,bhfd->bhqd", phi_q, kv)
        den = torch.einsum("bhqf,bhf->bhq", phi_q, z)[..., None] + 1e-6
        o = num / den
        return (lambda x, *d: x.permute(*d))(o, 0, 2, 1, 3).reshape(B, S, D) @ wo

    def _B_ref(x, w_gate, w_up, w_down):
        g = torch.einsum("bsd,df->bsf", x, w_gate)
        u = torch.einsum("bsd,df->bsf", x, w_up)
        h = _sigmoid(g) * u
        return torch.einsum("bsf,fd->bsd", h, w_down)

    x = A_x
    g = _sigmoid((x * gate_w).sum(-1, keepdims=True))
    a = _A_ref(x, A_wqkv, A_w_phi, A_wo)
    b = _B_ref(x, B_w_gate, B_w_up, B_w_down)
    return g * a + (1 - g) * b
```

```asm
; @launch grid=(256,1,1) block=(512,1,1) lds=149504
.amdgcn_target "amdgcn-amd-amdhsa--gfx950"
.text
.globl gated_mix__linear_kernel_hedgehog__glu_gated_glu__prompt_kernel
.p2align 8
.type gated_mix__linear_kernel_hedgehog__glu_gated_glu__prompt_kernel,@function
gated_mix__linear_kernel_hedgehog__glu_gated_glu__prompt_kernel:
    s_cmp_ge_u32 s2, 256
    s_cbranch_scc1 L_end
    s_load_dwordx4 s[4:7], s[0:1], 0
    s_load_dwordx4 s[12:15], s[0:1], 40
    v_lshrrev_b32 v14, 6, v0
    v_and_b32 v1, 63, v0
    v_readfirstlane_b32 s20, v14
    s_and_b32 s23, s2, 4
    s_bfe_u32 s62, s2, 0x20003
    s_add_u32 s23, s23, s62
    s_and_b32 s84, s2, 3
    s_lshr_b32 s85, s2, 5
    s_lshl_b32 s24, s84, 3
    s_add_u32 s24, s24, s85
    v_lshrrev_b32 v14, 3, v1
    v_and_b32 v15, 6, v14
    v_and_b32 v16, 7, v1
    v_xor_b32 v15, v15, v16
    v_lshlrev_b32 v15, 4, v15
    v_lshl_add_u32 v10, v14, 11, v15
    s_lshr_b32 s21, s20, 2
    s_and_b32 s22, s20, 3
    s_mov_b32 s52, 0
    s_mov_b32 s30, 524288
    s_mov_b32 s31, 0x20000
    s_mov_b32 s35, 0x20000
    s_mov_b32 s39, 0x20000
    s_mov_b32 s43, 0x20000
    s_lshl_b32 s69, s23, 19
    s_cmp_lt_u32 s20, 2
    s_cbranch_scc0 L_gu
    s_mul_i32 s60, s22, 3
    s_mul_i32 s61, s22, 192
    s_lshl_b32 s70, s24, 6
    s_movk_i32 s65, 5462
    s_movk_i32 s67, 6144
    v_add_u32 v14, s61, v1
    s_add_u32 s61, s61, 64
    v_mul_u32_u24 v15, s65, v14
    v_lshrrev_b32 v15, 16, v15
    v_mul_u32_u24 v16, 12, v15
    v_sub_u32 v16, v14, v16
    v_lshrrev_b32 v18, 1, v15
    v_xor_b32 v17, v18, v15
    v_and_b32 v17, 4, v17
    v_mul_u32_u24 v17, 3, v17
    v_xor_b32 v17, v17, v15
    v_and_b32 v18, 2, v18
    v_xor_b32 v18, v18, v16
    v_and_b32 v18, 3, v18
    v_lshrrev_b32 v16, 2, v16
    v_lshlrev_b32 v16, 11, v16
    v_lshl_add_u32 v16, v18, 4, v16
    v_mad_u32_u24 v16, v17, s67, v16
    v_add_u32 v11, s70, v16
    v_add_u32 v14, s61, v1
    s_add_u32 s61, s61, 64
    v_mul_u32_u24 v15, s65, v14
    v_lshrrev_b32 v15, 16, v15
    v_mul_u32_u24 v16, 12, v15
    v_sub_u32 v16, v14, v16
    v_lshrrev_b32 v18, 1, v15
    v_xor_b32 v17, v18, v15
    v_and_b32 v17, 4, v17
    v_mul_u32_u24 v17, 3, v17
    v_xor_b32 v17, v17, v15
    v_and_b32 v18, 2, v18
    v_xor_b32 v18, v18, v16
    v_and_b32 v18, 3, v18
    v_lshrrev_b32 v16, 2, v16
    v_lshlrev_b32 v16, 11, v16
    v_lshl_add_u32 v16, v18, 4, v16
    v_mad_u32_u24 v16, v17, s67, v16
    v_add_u32 v12, s70, v16
    v_add_u32 v14, s61, v1
    v_mul_u32_u24 v15, s65, v14
    v_lshrrev_b32 v15, 16, v15
    v_mul_u32_u24 v16, 12, v15
    v_sub_u32 v16, v14, v16
    v_lshrrev_b32 v18, 1, v15
    v_xor_b32 v17, v18, v15
    v_and_b32 v17, 4, v17
    v_mul_u32_u24 v17, 3, v17
    v_xor_b32 v17, v17, v15
    v_and_b32 v18, 2, v18
    v_xor_b32 v18, v18, v16
    v_and_b32 v18, 3, v18
    v_lshrrev_b32 v16, 2, v16
    v_lshlrev_b32 v16, 11, v16
    v_lshl_add_u32 v16, v18, 4, v16
    v_mad_u32_u24 v16, v17, s67, v16
    v_add_u32 v13, s70, v16
    s_mov_b32 s53, 196608
    s_mov_b32 s64, s60
    s_waitcnt lgkmcnt(0)
    s_mov_b64 s[32:33], s[6:7]
    s_mov_b32 s34, 6291456
    s_mov_b64 s[36:37], s[6:7]
    s_mov_b32 s38, 6291456
    s_mov_b64 s[40:41], s[6:7]
    s_mov_b32 s42, 6291456
    s_branch L_wdone
L_gu:
    s_mul_i32 s60, s22, 3
    s_lshl_b32 s61, s22, 1
    s_add_u32 s61, s61, 12
    s_mul_i32 s62, s22, 5
    s_add_u32 s62, s62, 12
    s_cmp_eq_u32 s21, 0
    s_cselect_b32 s64, s60, s62
    s_cselect_b32 s60, s60, s61
    s_mul_i32 s70, s24, 224
    s_movk_i32 s65, 4682
    s_movk_i32 s67, 7168
    s_add_u32 s72, s60, 0
    s_cmp_ge_u32 s72, 13
    s_cselect_b32 s73, 13, 6
    s_sub_u32 s73, s72, s73
    s_lshl_b32 s73, s73, 6
    v_add_u32 v14, s73, v1
    v_mul_u32_u24 v15, s65, v14
    v_lshrrev_b32 v15, 16, v15
    v_mul_u32_u24 v16, 14, v15
    v_sub_u32 v16, v14, v16
    v_lshrrev_b32 v18, 1, v15
    v_xor_b32 v17, v18, v15
    v_and_b32 v17, 4, v17
    v_mul_u32_u24 v17, 3, v17
    v_xor_b32 v17, v17, v15
    v_lshlrev_b32 v16, 4, v16
    v_mad_u32_u24 v16, v17, s67, v16
    v_add_u32 v11, s70, v16
    s_add_u32 s72, s60, 1
    s_cmp_ge_u32 s72, 13
    s_cselect_b32 s73, 13, 6
    s_sub_u32 s73, s72, s73
    s_lshl_b32 s73, s73, 6
    v_add_u32 v14, s73, v1
    v_mul_u32_u24 v15, s65, v14
    v_lshrrev_b32 v15, 16, v15
    v_mul_u32_u24 v16, 14, v15
    v_sub_u32 v16, v14, v16
    v_lshrrev_b32 v18, 1, v15
    v_xor_b32 v17, v18, v15
    v_and_b32 v17, 4, v17
    v_mul_u32_u24 v17, 3, v17
    v_xor_b32 v17, v17, v15
    v_lshlrev_b32 v16, 4, v16
    v_mad_u32_u24 v16, v17, s67, v16
    v_add_u32 v12, s70, v16
    s_add_u32 s72, s60, 2
    s_cmp_ge_u32 s72, 13
    s_cselect_b32 s73, 13, 6
    s_sub_u32 s73, s72, s73
    s_lshl_b32 s73, s73, 6
    v_add_u32 v14, s73, v1
    v_mul_u32_u24 v15, s65, v14
    v_lshrrev_b32 v15, 16, v15
    v_mul_u32_u24 v16, 14, v15
    v_sub_u32 v16, v14, v16
    v_lshrrev_b32 v18, 1, v15
    v_xor_b32 v17, v18, v15
    v_and_b32 v17, 4, v17
    v_mul_u32_u24 v17, 3, v17
    v_xor_b32 v17, v17, v15
    v_lshlrev_b32 v16, 4, v16
    v_mad_u32_u24 v16, v17, s67, v16
    v_add_u32 v13, s70, v16
    s_mov_b32 s53, 229376
    s_waitcnt lgkmcnt(0)
    s_cmp_ge_u32 s60, 13
    s_cselect_b64 s[32:33], s[14:15], s[12:13]
    s_mov_b32 s34, 7340032
    s_cmp_ge_u32 s60, 12
    s_cselect_b64 s[36:37], s[14:15], s[12:13]
    s_mov_b32 s38, 7340032
    s_cmp_ge_u32 s60, 11
    s_cselect_b64 s[40:41], s[14:15], s[12:13]
    s_mov_b32 s42, 7340032
L_wdone:
    s_add_u32 s28, s4, s69
    s_addc_u32 s29, s5, 0
    s_lshl_b32 s54, s60, 10
    s_add_u32 s54, s54, 65536
    s_lshl_b32 s56, s64, 10
    s_lshl_b32 s55, s64, 14
    s_cmp_eq_u32 s21, 0
    s_cbranch_scc0 L_half1
    s_add_u32 m0, s56, 0
    s_add_u32 s60, s55, 0
    buffer_load_dwordx4 v10, s[28:31], s60 offen lds
    s_add_u32 m0, s56, 1024
    s_add_u32 s60, s55, 16384
    buffer_load_dwordx4 v10, s[28:31], s60 offen lds
    s_add_u32 m0, s56, 2048
    s_add_u32 s60, s55, 32768
    buffer_load_dwordx4 v10, s[28:31], s60 offen lds
    s_add_u32 s55, s55, 128
    s_add_u32 m0, s54, 0
    s_nop 0
    buffer_load_dwordx4 v11, s[32:35], s52 offen lds
    s_add_u32 m0, s54, 1024
    s_nop 0
    buffer_load_dwordx4 v12, s[36:39], s52 offen lds
    s_add_u32 m0, s54, 2048
    s_nop 0
    buffer_load_dwordx4 v13, s[40:43], s52 offen lds
    s_add_u32 s52, s52, s53
    s_load_dwordx4 s[8:11], s[0:1], 16
    s_load_dwordx4 s[72:75], s[0:1], 56
    s_load_dwordx2 s[80:81], s[0:1], 72
    s_load_dwordx4 s[16:19], s[0:1], 80
    v_lshrrev_b32 v14, 4, v1
    v_bfe_u32 v15, v1, 2, 2
    v_and_b32 v16, 3, v1
    v_lshrrev_b32 v17, 1, v14
    v_and_b32 v18, 1, v14
    v_lshlrev_b32 v19, 4, v17
    v_lshl_add_u32 v19, v18, 2, v19
    v_add_u32 v19, v19, v15
    v_mul_u32_u24 v20, 224, v19
    v_lshl_add_u32 v20, v16, 3, v20
    v_add_u32 v4, 65536, v20
    v_add_u32 v5, 106496, v20
    v_mul_u32_u24 v20, 192, v19
    v_lshl_add_u32 v20, v16, 3, v20
    v_lshlrev_b32 v21, 5, v18
    v_xor_b32 v22, 32, v21
    v_add_u32 v21, v20, v21
    v_add_u32 v22, v20, v22
    v_add_u32 v6, 65536, v21
    v_add_u32 v7, 106496, v21
    v_add_u32 v8, 65536, v22
    v_add_u32 v9, 106496, v22
    v_and_b32 v19, 15, v1
    v_and_b32 v20, 6, v1
    v_xor_b32 v20, v20, v14
    v_lshlrev_b32 v20, 4, v20
    v_lshl_add_u32 v20, v19, 7, v20
    s_lshl_b32 s61, s22, 13
    v_add_u32 v2, s61, v20
    v_xor_b32 v3, 64, v2
    s_add_u32 m0, s54, 20480
    s_nop 0
    buffer_load_dwordx4 v11, s[32:35], s52 offen lds
    s_add_u32 m0, s54, 21504
    s_nop 0
    buffer_load_dwordx4 v12, s[36:39], s52 offen lds
    s_add_u32 m0, s54, 22528
    s_nop 0
    buffer_load_dwordx4 v13, s[40:43], s52 offen lds
    s_add_u32 s52, s52, s53
    v_mov_b32 v240, -1
    v_mov_b32 v241, -1
    v_mov_b32 v242, -1
    v_mov_b32 v243, -1
    v_lshlrev_b32 v15, 4, v1
    v_and_b32 v244, 0x30, v1
    v_lshlrev_b32 v245, 2, v0
    s_lshl_b32 s25, s23, 3
    s_add_u32 s25, s25, s85
    s_lshl_b32 s25, s25, 2
    s_add_u32 s25, s25, s84
    s_mul_i32 s25, s25, 49152
    s_lshl_b32 s61, s20, 11
    s_add_u32 s25, s25, s61
    s_add_u32 s25, s25, 23068672
    s_lshl_b32 s95, s23, 3
    s_add_u32 s95, s95, s85
    s_lshl_b32 s95, s95, 3
    s_add_u32 s95, s95, s20
    s_lshl_b32 s95, s95, 2
    s_add_u32 s95, s95, s84
    s_lshl_b32 s95, s95, 6
    s_add_u32 s95, s95, 19136512
    s_getreg_b32 s82, hwreg(HW_REG_XCC_ID, 0, 4)
    s_and_b32 s82, s82, 7
    s_add_u32 s82, s82, 1
    v_and_b32 v16, 31, v1
    v_lshl_add_u32 v16, v16, 3, s23
    v_and_b32 v17, 7, v1
    s_lshl_b32 s61, s24, 3
    v_add_u32 v17, s61, v17
    v_cmp_gt_u32 vcc, 32, v1
    s_nop 1
    v_cndmask_b32 v248, v17, v16, vcc
    v_mov_b32 v249, 0
    s_lshl_b32 s3, s23, 5
    s_add_u32 s3, s3, s24
    s_lshl_b32 s3, s3, 7
    s_add_u32 s3, s3, 19005440
    s_cmp_eq_u32 s20, 0
    s_cselect_b32 s60, 64, 224
    s_cselect_b32 s61, 64, 32
    s_mul_i32 s60, s60, s2
    s_lshl_b32 s62, s20, 5
    s_max_u32 s62, s62, 32
    s_add_u32 s60, s60, s62
    s_sub_u32 s60, s60, 32
    v_add_u32 v14, s60, v1
    v_lshlrev_b32 v14, 7, v14
    v_cmp_gt_u32 vcc, s61, v1
    s_nop 1
    v_cndmask_b32 v14, -1, v14, vcc
    s_waitcnt lgkmcnt(0)
    s_mov_b64 s[4:5], s[16:17]
    s_mov_b32 s6, 256
    s_mov_b32 s7, 0x20000
    s_mov_b64 s[44:45], s[18:19]
    s_mov_b32 s46, 0x10000000
    s_mov_b32 s47, 0x20000
    s_lshl_b32 s60, s24, 11
    s_add_u32 s48, s8, s60
    s_addc_u32 s49, s9, 0
    s_mov_b32 s50, 2048
    s_mov_b32 s51, 0x20000
    s_cmp_eq_u32 s20, 0
    s_cselect_b64 s[76:77], s[10:11], s[72:73]
    s_mov_b32 s78, 7340032
    s_cselect_b32 s78, 2097152, s78
    s_mov_b32 s79, 0x20000
    s_lshl_b32 s60, s22, 13
    s_mul_i32 s86, s84, 1835008
    s_add_u32 s86, s86, s60
    s_mul_i32 s87, s21, 229376
    s_add_u32 s87, s87, s86
    s_add_u32 s87, s87, 196608
    s_lshl_b32 s88, s84, 19
    s_add_u32 s88, s88, s60
    s_lshl_b32 s60, s21, 15
    s_add_u32 s86, s86, s60
    s_add_u32 s88, s88, s60
    s_lshl_b32 s91, s20, 10
    s_add_u32 s91, s91, 65536
    s_lshl_b32 s60, s23, 1
    s_add_u32 s60, s60, s21
    s_mul_i32 s60, s60, 1179648
    s_lshl_b32 s61, s22, 11
    s_add_u32 s60, s60, s61
    s_mul_i32 s89, s84, 196608
    s_add_u32 s89, s89, 262144
    s_add_u32 s89, s89, s60
    s_lshl_b32 s90, s84, 15
    s_add_u32 s90, s90, 1048576
    s_add_u32 s90, s90, s60
    s_lshl_b32 s92, s84, 16
    s_add_u32 s92, s92, s60
    s_lshl_b32 s93, s24, 13
    s_add_u32 s93, s93, s60
    s_lshl_b32 s13, s23, 12
    s_lshl_b32 s60, s20, 9
    s_add_u32 s13, s13, s60
    s_add_u32 s13, s13, 18939904
    s_lshl_b32 s94, s24, 16
    s_lshl_b32 s60, s20, 10
    s_add_u32 s94, s94, s60
    s_add_u32 s94, s94, 20971520
    s_lshl_b32 s12, s24, 11
    s_lshr_b32 s60, s20, 1
    s_lshl_b32 s61, s60, 6
    s_add_u32 s12, s12, s61
    s_add_u32 s12, s12, 18874368
    s_lshr_b32 s60, s22, 1
    s_lshl_b32 s61, s23, 1
    s_add_u32 s60, s60, s61
    s_mul_i32 s26, s60, 1179648
    s_and_b32 s60, s22, 1
    s_lshl_b32 s60, s60, 12
    s_add_u32 s26, s26, s60
    s_mov_b32 s58, 1069066811
    s_mov_b32 s59, 1069066811
    s_waitcnt vmcnt(3)
    s_barrier
    ds_read_b64_tr_b16 v[48:49], v6 offset:0
    ds_read_b64_tr_b16 v[50:51], v6 offset:1536
    ds_read_b128 v[16:19], v2 offset:0
    ds_read_b128 v[20:23], v2 offset:2048
    ds_read_b128 v[24:27], v2 offset:4096
    ds_read_b128 v[28:31], v2 offset:6144
    ds_read_b64_tr_b16 v[52:53], v8 offset:0
    ds_read_b64_tr_b16 v[54:55], v8 offset:1536
    ds_read_b64_tr_b16 v[56:57], v6 offset:64
    ds_read_b64_tr_b16 v[58:59], v6 offset:1600
    ds_read_b64_tr_b16 v[60:61], v8 offset:64
    ds_read_b64_tr_b16 v[62:63], v8 offset:1600
    ds_read_b64_tr_b16 v[64:65], v6 offset:128
    ds_read_b64_tr_b16 v[66:67], v6 offset:1664
    s_mov_b32 s57, 8
    s_waitcnt lgkmcnt(11)
    v_mfma_f32_16x16x32_bf16 v[80:83], v[48:51], v[16:19], 0
    ds_read_b64_tr_b16 v[68:69], v8 offset:128
    ds_read_b64_tr_b16 v[70:71], v8 offset:1664
    s_waitcnt lgkmcnt(12)
    v_mfma_f32_16x16x32_bf16 v[84:87], v[48:51], v[20:23], 0
    ds_read_b128 v[32:35], v3 offset:0
    s_waitcnt lgkmcnt(12)
    v_mfma_f32_16x16x32_bf16 v[88:91], v[48:51], v[24:27], 0
    s_add_u32 m0, s56, 32768
    s_add_u32 s60, s55, 0
    buffer_load_dwordx4 v10, s[28:31], s60 offen lds
    s_waitcnt lgkmcnt(11)
    v_mfma_f32_16x16x32_bf16 v[92:95], v[48:51], v[28:31], 0
    s_add_u32 m0, s56, 33792
    s_add_u32 s60, s55, 16384
    buffer_load_dwordx4 v10, s[28:31], s60 offen lds
    s_waitcnt lgkmcnt(9)
    v_mfma_f32_16x16x32_bf16 v[108:111], v[52:55], v[28:31], 0
    ds_read_b64_tr_b16 v[72:73], v4 offset:6144
    v_mfma_f32_16x16x32_bf16 v[104:107], v[52:55], v[24:27], 0
    ds_read_b64_tr_b16 v[74:75], v4 offset:7936
    v_mfma_f32_16x16x32_bf16 v[100:103], v[52:55], v[20:23], 0
    ds_read_b128 v[36:39], v3 offset:2048
    v_mfma_f32_16x16x32_bf16 v[96:99], v[52:55], v[16:19], 0
    s_add_u32 m0, s56, 34816
    s_add_u32 s60, s55, 32768
    buffer_load_dwordx4 v10, s[28:31], s60 offen lds
    s_add_u32 s55, s55, 128
    s_waitcnt lgkmcnt(10)
    v_mfma_f32_16x16x32_bf16 v[112:115], v[56:59], v[16:19], 0
    ds_read_b64_tr_b16 v[76:77], v4 offset:6176
    ds_read_b64_tr_b16 v[78:79], v4 offset:7968
    v_mfma_f32_16x16x32_bf16 v[116:119], v[56:59], v[20:23], 0
    ds_read_b128 v[40:43], v3 offset:4096
    v_mfma_f32_16x16x32_bf16 v[120:123], v[56:59], v[24:27], 0
    s_add_u32 m0, s54, 40960
    s_nop 0
    buffer_load_dwordx4 v11, s[32:35], s52 offen lds
    v_mfma_f32_16x16x32_bf16 v[124:127], v[56:59], v[28:31], 0
    s_add_u32 m0, s54, 41984
    s_nop 0
    buffer_load_dwordx4 v12, s[36:39], s52 offen lds
    s_waitcnt lgkmcnt(11)
    v_mfma_f32_16x16x32_bf16 v[140:143], v[60:63], v[28:31], 0
    ds_read_b64_tr_b16 v[48:49], v4 offset:13312
    v_mfma_f32_16x16x32_bf16 v[136:139], v[60:63], v[24:27], 0
    ds_read_b64_tr_b16 v[50:51], v4 offset:15104
    v_mfma_f32_16x16x32_bf16 v[132:135], v[60:63], v[20:23], 0
    ds_read_b128 v[44:47], v3 offset:6144
    v_mfma_f32_16x16x32_bf16 v[128:131], v[60:63], v[16:19], 0
    s_add_u32 m0, s54, 43008
    s_nop 0
    buffer_load_dwordx4 v13, s[40:43], s52 offen lds
    s_add_u32 s52, s52, s53
    s_waitcnt lgkmcnt(12)
    v_mfma_f32_16x16x32_bf16 v[144:147], v[16:19], v[64:67], 0
    ds_read_b64_tr_b16 v[52:53], v4 offset:13344
    v_mfma_f32_16x16x32_bf16 v[148:151], v[20:23], v[64:67], 0
    ds_read_b64_tr_b16 v[54:55], v4 offset:15136
    v_mfma_f32_16x16x32_bf16 v[152:155], v[24:27], v[64:67], 0
    s_add_u32 m0, s54, 61440
    s_nop 0
    buffer_load_dwordx4 v11, s[32:35], s52 offen lds
    v_mfma_f32_16x16x32_bf16 v[156:159], v[28:31], v[64:67], 0
    s_add_u32 m0, s54, 62464
    s_nop 0
    buffer_load_dwordx4 v12, s[36:39], s52 offen lds
    s_waitcnt lgkmcnt(12)
    v_mfma_f32_16x16x32_bf16 v[172:175], v[28:31], v[68:71], 0
    s_add_u32 m0, s54, 63488
    s_nop 0
    buffer_load_dwordx4 v13, s[40:43], s52 offen lds
    s_add_u32 s52, s52, s53
    v_mfma_f32_16x16x32_bf16 v[168:171], v[24:27], v[68:71], 0
    v_mfma_f32_16x16x32_bf16 v[164:167], v[20:23], v[68:71], 0
    v_mfma_f32_16x16x32_bf16 v[160:163], v[16:19], v[68:71], 0
    s_waitcnt lgkmcnt(9)
    v_mfma_f32_16x16x32_bf16 v[176:179], v[72:75], v[16:19], 0
    s_lshl_b32 s60, s20, 8
    s_add_u32 m0, s60, 147456
    s_nop 0
    buffer_load_dword v245, s[48:51], 0 offen lds
    v_mfma_f32_16x16x32_bf16 v[180:183], v[72:75], v[20:23], 0
    v_mfma_f32_16x16x32_bf16 v[184:187], v[72:75], v[24:27], 0
    v_mfma_f32_16x16x32_bf16 v[188:191], v[72:75], v[28:31], 0
    s_waitcnt vmcnt(10) lgkmcnt(0)
    s_barrier
    v_mfma_f32_16x16x32_bf16 v[204:207], v[76:79], v[28:31], 0
    ds_read_b64_tr_b16 v[56:57], v6 offset:20480
    v_mfma_f32_16x16x32_bf16 v[200:203], v[76:79], v[24:27], 0
    ds_read_b64_tr_b16 v[58:59], v6 offset:22016
    v_mfma_f32_16x16x32_bf16 v[196:199], v[76:79], v[20:23], 0
    ds_read_b64_tr_b16 v[60:61], v8 offset:20480
    v_mfma_f32_16x16x32_bf16 v[192:195], v[76:79], v[16:19], 0
    ds_read_b64_tr_b16 v[62:63], v8 offset:22016
    v_mfma_f32_16x16x32_bf16 v[208:211], v[48:51], v[16:19], 0
    ds_read_b64_tr_b16 v[64:65], v6 offset:20544
    v_mfma_f32_16x16x32_bf16 v[212:215], v[48:51], v[20:23], 0
    ds_read_b64_tr_b16 v[66:67], v6 offset:22080
    v_mfma_f32_16x16x32_bf16 v[216:219], v[48:51], v[24:27], 0
    ds_read_b64_tr_b16 v[68:69], v8 offset:20544
    v_mfma_f32_16x16x32_bf16 v[220:223], v[48:51], v[28:31], 0
    ds_read_b64_tr_b16 v[70:71], v8 offset:22080
    v_mfma_f32_16x16x32_bf16 v[236:239], v[52:55], v[28:31], 0
    ds_read_b64_tr_b16 v[72:73], v6 offset:20608
    v_mfma_f32_16x16x32_bf16 v[232:235], v[52:55], v[24:27], 0
    ds_read_b64_tr_b16 v[74:75], v6 offset:22144
    v_mfma_f32_16x16x32_bf16 v[228:231], v[52:55], v[20:23], 0
    v_mfma_f32_16x16x32_bf16 v[224:227], v[52:55], v[16:19], 0
    s_branch L_loop0_u1
    .p2align 6
L_loop0:
    s_waitcnt lgkmcnt(11)
    v_mfma_f32_16x16x32_bf16 v[80:83], v[48:51], v[16:19], v[80:83]
    ds_read_b64_tr_b16 v[68:69], v8 offset:128
    s_waitcnt lgkmcnt(11)
    v_mfma_f32_16x16x32_bf16 v[84:87], v[48:51], v[20:23], v[84:87]
    ds_read_b64_tr_b16 v[70:71], v8 offset:1664
    s_waitcnt lgkmcnt(11)
    v_mfma_f32_16x16x32_bf16 v[88:91], v[48:51], v[24:27], v[88:91]
    ds_read_b128 v[32:35], v3 offset:0
    s_waitcnt lgkmcnt(11)
    v_mfma_f32_16x16x32_bf16 v[92:95], v[48:51], v[28:31], v[92:95]
    s_waitcnt lgkmcnt(9)
    v_mfma_f32_16x16x32_bf16 v[108:111], v[52:55], v[28:31], v[108:111]
    ds_read_b64_tr_b16 v[72:73], v4 offset:6144
    v_mfma_f32_16x16x32_bf16 v[104:107], v[52:55], v[24:27], v[104:107]
    ds_read_b64_tr_b16 v[74:75], v4 offset:7936
    v_mfma_f32_16x16x32_bf16 v[100:103], v[52:55], v[20:23], v[100:103]
    ds_read_b128 v[36:39], v3 offset:2048
    v_mfma_f32_16x16x32_bf16 v[96:99], v[52:55], v[16:19], v[96:99]
    s_add_u32 m0, s54, 61440
    s_nop 0
    buffer_load_dwordx4 v11, s[32:35], s52 offen lds
    s_waitcnt lgkmcnt(10)
    v_mfma_f32_16x16x32_bf16 v[112:115], v[56:59], v[16:19], v[112:115]
    ds_read_b64_tr_b16 v[76:77], v4 offset:6176
    v_mfma_f32_16x16x32_bf16 v[116:119], v[56:59], v[20:23], v[116:119]
    ds_read_b64_tr_b16 v[78:79], v4 offset:7968
    v_mfma_f32_16x16x32_bf16 v[120:123], v[56:59], v[24:27], v[120:123]
    ds_read_b128 v[40:43], v3 offset:4096
    v_mfma_f32_16x16x32_bf16 v[124:127], v[56:59], v[28:31], v[124:127]
    s_waitcnt lgkmcnt(11)
    v_mfma_f32_16x16x32_bf16 v[140:143], v[60:63], v[28:31], v[140:143]
    ds_read_b64_tr_b16 v[48:49], v4 offset:13312
    v_mfma_f32_16x16x32_bf16 v[136:139], v[60:63], v[24:27], v[136:139]
    ds_read_b64_tr_b16 v[50:51], v4 offset:15104
    v_mfma_f32_16x16x32_bf16 v[132:135], v[60:63], v[20:23], v[132:135]
    ds_read_b128 v[44:47], v3 offset:6144
    v_mfma_f32_16x16x32_bf16 v[128:131], v[60:63], v[16:19], v[128:131]
    s_add_u32 m0, s54, 62464
    s_nop 0
    buffer_load_dwordx4 v12, s[36:39], s52 offen lds
    s_waitcnt lgkmcnt(12)
    v_mfma_f32_16x16x32_bf16 v[144:147], v[16:19], v[64:67], v[144:147]
    ds_read_b64_tr_b16 v[52:53], v4 offset:13344
    v_mfma_f32_16x16x32_bf16 v[148:151], v[20:23], v[64:67], v[148:151]
    ds_read_b64_tr_b16 v[54:55], v4 offset:15136
    v_mfma_f32_16x16x32_bf16 v[152:155], v[24:27], v[64:67], v[152:155]
    v_mfma_f32_16x16x32_bf16 v[156:159], v[28:31], v[64:67], v[156:159]
    s_waitcnt lgkmcnt(12)
    v_mfma_f32_16x16x32_bf16 v[172:175], v[28:31], v[68:71], v[172:175]
    s_add_u32 m0, s54, 63488
    s_nop 0
    buffer_load_dwordx4 v13, s[40:43], s52 offen lds
    s_add_u32 s52, s52, s53
    v_mfma_f32_16x16x32_bf16 v[168:171], v[24:27], v[68:71], v[168:171]
    v_mfma_f32_16x16x32_bf16 v[164:167], v[20:23], v[68:71], v[164:167]
    v_mfma_f32_16x16x32_bf16 v[160:163], v[16:19], v[68:71], v[160:163]
    s_waitcnt lgkmcnt(9)
    v_mfma_f32_16x16x32_bf16 v[176:179], v[72:75], v[16:19], v[176:179]
    v_mfma_f32_16x16x32_bf16 v[180:183], v[72:75], v[20:23], v[180:183]
    v_mfma_f32_16x16x32_bf16 v[184:187], v[72:75], v[24:27], v[184:187]
    v_mfma_f32_16x16x32_bf16 v[188:191], v[72:75], v[28:31], v[188:191]
    s_waitcnt vmcnt(9) lgkmcnt(0)
    s_barrier
    v_mfma_f32_16x16x32_bf16 v[204:207], v[76:79], v[28:31], v[204:207]
    ds_read_b64_tr_b16 v[56:57], v6 offset:20480
    v_mfma_f32_16x16x32_bf16 v[200:203], v[76:79], v[24:27], v[200:203]
    ds_read_b64_tr_b16 v[58:59], v6 offset:22016
    v_mfma_f32_16x16x32_bf16 v[196:199], v[76:79], v[20:23], v[196:199]
    ds_read_b64_tr_b16 v[60:61], v8 offset:20480
    v_mfma_f32_16x16x32_bf16 v[192:195], v[76:79], v[16:19], v[192:195]
    ds_read_b64_tr_b16 v[62:63], v8 offset:22016
    v_mfma_f32_16x16x32_bf16 v[208:211], v[48:51], v[16:19], v[208:211]
    ds_read_b64_tr_b16 v[64:65], v6 offset:20544
    v_mfma_f32_16x16x32_bf16 v[212:215], v[48:51], v[20:23], v[212:215]
    ds_read_b64_tr_b16 v[66:67], v6 offset:22080
    v_mfma_f32_16x16x32_bf16 v[216:219], v[48:51], v[24:27], v[216:219]
    ds_read_b64_tr_b16 v[68:69], v8 offset:20544
    v_mfma_f32_16x16x32_bf16 v[220:223], v[48:51], v[28:31], v[220:223]
    ds_read_b64_tr_b16 v[70:71], v8 offset:22080
    v_mfma_f32_16x16x32_bf16 v[236:239], v[52:55], v[28:31], v[236:239]
    ds_read_b64_tr_b16 v[72:73], v6 offset:20608
    v_mfma_f32_16x16x32_bf16 v[232:235], v[52:55], v[24:27], v[232:235]
    ds_read_b64_tr_b16 v[74:75], v6 offset:22144
    v_mfma_f32_16x16x32_bf16 v[228:231], v[52:55], v[20:23], v[228:231]
    v_mfma_f32_16x16x32_bf16 v[224:227], v[52:55], v[16:19], v[224:227]
L_loop0_u1:
    s_cmp_eq_u32 s57, 7
    s_cbranch_scc0 L_loop0_j7
    s_mov_b64 exec, 1
    buffer_store_dword v249, off, s[44:47], s95 sc1
    s_mov_b64 exec, -1
L_loop0_j7:
    s_cmp_eq_u32 s57, 1
    s_cbranch_scc0 L_loop0_j1
    s_mov_b32 s54, 163840
    s_mov_b32 s56, 163840
    s_mov_b32 s55, 0x40000000
    buffer_load_ubyte v247, v248, s[4:7], 0 offen sc1
    buffer_load_dword v246, v14, s[76:79], 0 offen
L_loop0_j1:
    s_waitcnt lgkmcnt(8)
    v_mfma_f32_16x16x32_bf16 v[80:83], v[56:59], v[32:35], v[80:83]
    ds_read_b64_tr_b16 v[76:77], v8 offset:20608
    v_mfma_f32_16x16x32_bf16 v[84:87], v[56:59], v[36:39], v[84:87]
    ds_read_b64_tr_b16 v[78:79], v8 offset:22144
    v_mfma_f32_16x16x32_bf16 v[88:91], v[56:59], v[40:43], v[88:91]
    s_add_u32 m0, s56, 0
    s_add_u32 s60, s55, 0
    buffer_load_dwordx4 v10, s[28:31], s60 offen lds
    v_mfma_f32_16x16x32_bf16 v[92:95], v[56:59], v[44:47], v[92:95]
    s_waitcnt lgkmcnt(8)
    v_mfma_f32_16x16x32_bf16 v[108:111], v[60:63], v[44:47], v[108:111]
    ds_read_b64_tr_b16 v[48:49], v4 offset:26624
    v_mfma_f32_16x16x32_bf16 v[104:107], v[60:63], v[40:43], v[104:107]
    ds_read_b64_tr_b16 v[50:51], v4 offset:28416
    v_mfma_f32_16x16x32_bf16 v[100:103], v[60:63], v[36:39], v[100:103]
    s_add_u32 m0, s56, 1024
    s_add_u32 s60, s55, 16384
    buffer_load_dwordx4 v10, s[28:31], s60 offen lds
    v_mfma_f32_16x16x32_bf16 v[96:99], v[60:63], v[32:35], v[96:99]
    s_waitcnt lgkmcnt(8)
    v_mfma_f32_16x16x32_bf16 v[112:115], v[64:67], v[32:35], v[112:115]
    ds_read_b64_tr_b16 v[52:53], v4 offset:26656
    v_mfma_f32_16x16x32_bf16 v[116:119], v[64:67], v[36:39], v[116:119]
    ds_read_b64_tr_b16 v[54:55], v4 offset:28448
    v_mfma_f32_16x16x32_bf16 v[120:123], v[64:67], v[40:43], v[120:123]
    s_add_u32 m0, s56, 2048
    s_add_u32 s60, s55, 32768
    buffer_load_dwordx4 v10, s[28:31], s60 offen lds
    s_add_u32 s55, s55, 128
    v_mfma_f32_16x16x32_bf16 v[124:127], v[64:67], v[44:47], v[124:127]
    s_waitcnt lgkmcnt(8)
    v_mfma_f32_16x16x32_bf16 v[140:143], v[68:71], v[44:47], v[140:143]
    ds_read_b64_tr_b16 v[56:57], v4 offset:33792
    v_mfma_f32_16x16x32_bf16 v[136:139], v[68:71], v[40:43], v[136:139]
    ds_read_b64_tr_b16 v[58:59], v4 offset:35584
    v_mfma_f32_16x16x32_bf16 v[132:135], v[68:71], v[36:39], v[132:135]
    s_add_u32 m0, s54, 0
    s_nop 0
    buffer_load_dwordx4 v11, s[32:35], s52 offen lds
    v_mfma_f32_16x16x32_bf16 v[128:131], v[68:71], v[32:35], v[128:131]
    s_waitcnt lgkmcnt(8)
    v_mfma_f32_16x16x32_bf16 v[144:147], v[32:35], v[72:75], v[144:147]
    ds_read_b64_tr_b16 v[60:61], v4 offset:33824
    v_mfma_f32_16x16x32_bf16 v[148:151], v[36:39], v[72:75], v[148:151]
    ds_read_b64_tr_b16 v[62:63], v4 offset:35616
    v_mfma_f32_16x16x32_bf16 v[152:155], v[40:43], v[72:75], v[152:155]
    s_add_u32 m0, s54, 1024
    s_nop 0
    buffer_load_dwordx4 v12, s[36:39], s52 offen lds
    v_mfma_f32_16x16x32_bf16 v[156:159], v[44:47], v[72:75], v[156:159]
    s_waitcnt lgkmcnt(8)
    v_mfma_f32_16x16x32_bf16 v[172:175], v[44:47], v[76:79], v[172:175]
    s_add_u32 m0, s54, 2048
    s_nop 0
    buffer_load_dwordx4 v13, s[40:43], s52 offen lds
    s_add_u32 s52, s52, s53
    v_mfma_f32_16x16x32_bf16 v[168:171], v[40:43], v[76:79], v[168:171]
    v_mfma_f32_16x16x32_bf16 v[164:167], v[36:39], v[76:79], v[164:167]
    v_mfma_f32_16x16x32_bf16 v[160:163], v[32:35], v[76:79], v[160:163]
    s_waitcnt lgkmcnt(6)
    v_mfma_f32_16x16x32_bf16 v[176:179], v[48:51], v[32:35], v[176:179]
    v_mfma_f32_16x16x32_bf16 v[180:183], v[48:51], v[36:39], v[180:183]
    v_mfma_f32_16x16x32_bf16 v[184:187], v[48:51], v[40:43], v[184:187]
    v_mfma_f32_16x16x32_bf16 v[188:191], v[48:51], v[44:47], v[188:191]
    s_cmp_eq_u32 s57, 1
    s_cbranch_scc1 L_loop0_r1
    s_waitcnt vmcnt(9)
L_loop0_r1:
    s_waitcnt vmcnt(8) lgkmcnt(0)
    s_barrier
    s_cbranch_scc1 L_tail0
    v_mfma_f32_16x16x32_bf16 v[204:207], v[52:55], v[44:47], v[204:207]
    ds_read_b64_tr_b16 v[64:65], v7 offset:0
    ds_read_b64_tr_b16 v[66:67], v7 offset:1536
    v_mfma_f32_16x16x32_bf16 v[200:203], v[52:55], v[40:43], v[200:203]
    ds_read_b128 v[16:19], v2 offset:32768
    v_mfma_f32_16x16x32_bf16 v[196:199], v[52:55], v[36:39], v[196:199]
    ds_read_b128 v[20:23], v2 offset:34816
    v_mfma_f32_16x16x32_bf16 v[192:195], v[52:55], v[32:35], v[192:195]
    ds_read_b128 v[24:27], v2 offset:36864
    v_mfma_f32_16x16x32_bf16 v[208:211], v[56:59], v[32:35], v[208:211]
    ds_read_b128 v[28:31], v2 offset:38912
    ds_read_b64_tr_b16 v[68:69], v9 offset:0
    v_mfma_f32_16x16x32_bf16 v[212:215], v[56:59], v[36:39], v[212:215]
    ds_read_b64_tr_b16 v[70:71], v9 offset:1536
    v_mfma_f32_16x16x32_bf16 v[216:219], v[56:59], v[40:43], v[216:219]
    ds_read_b64_tr_b16 v[72:73], v7 offset:64
    v_mfma_f32_16x16x32_bf16 v[220:223], v[56:59], v[44:47], v[220:223]
    ds_read_b64_tr_b16 v[74:75], v7 offset:1600
    v_mfma_f32_16x16x32_bf16 v[236:239], v[60:63], v[44:47], v[236:239]
    ds_read_b64_tr_b16 v[76:77], v9 offset:64
    v_mfma_f32_16x16x32_bf16 v[232:235], v[60:63], v[40:43], v[232:235]
    ds_read_b64_tr_b16 v[78:79], v9 offset:1600
    v_mfma_f32_16x16x32_bf16 v[228:231], v[60:63], v[36:39], v[228:231]
    ds_read_b64_tr_b16 v[48:49], v7 offset:128
    v_mfma_f32_16x16x32_bf16 v[224:227], v[60:63], v[32:35], v[224:227]
    ds_read_b64_tr_b16 v[50:51], v7 offset:1664
    s_waitcnt lgkmcnt(11)
    v_mfma_f32_16x16x32_bf16 v[80:83], v[64:67], v[16:19], v[80:83]
    ds_read_b64_tr_b16 v[52:53], v9 offset:128
    s_waitcnt lgkmcnt(11)
    v_mfma_f32_16x16x32_bf16 v[84:87], v[64:67], v[20:23], v[84:87]
    ds_read_b64_tr_b16 v[54:55], v9 offset:1664
    s_waitcnt lgkmcnt(11)
    v_mfma_f32_16x16x32_bf16 v[88:91], v[64:67], v[24:27], v[88:91]
    ds_read_b128 v[32:35], v3 offset:32768
    s_waitcnt lgkmcnt(11)
    v_mfma_f32_16x16x32_bf16 v[92:95], v[64:67], v[28:31], v[92:95]
    s_waitcnt lgkmcnt(9)
    v_mfma_f32_16x16x32_bf16 v[108:111], v[68:71], v[28:31], v[108:111]
    ds_read_b64_tr_b16 v[56:57], v5 offset:6144
    v_mfma_f32_16x16x32_bf16 v[104:107], v[68:71], v[24:27], v[104:107]
    ds_read_b64_tr_b16 v[58:59], v5 offset:7936
    v_mfma_f32_16x16x32_bf16 v[100:103], v[68:71], v[20:23], v[100:103]
    ds_read_b128 v[36:39], v3 offset:34816
    v_mfma_f32_16x16x32_bf16 v[96:99], v[68:71], v[16:19], v[96:99]
    s_add_u32 m0, s54, 20480
    s_nop 0
    buffer_load_dwordx4 v11, s[32:35], s52 offen lds
    s_waitcnt lgkmcnt(10)
    v_mfma_f32_16x16x32_bf16 v[112:115], v[72:75], v[16:19], v[112:115]
    ds_read_b64_tr_b16 v[60:61], v5 offset:6176
    v_mfma_f32_16x16x32_bf16 v[116:119], v[72:75], v[20:23], v[116:119]
    ds_read_b64_tr_b16 v[62:63], v5 offset:7968
    v_mfma_f32_16x16x32_bf16 v[120:123], v[72:75], v[24:27], v[120:123]
    ds_read_b128 v[40:43], v3 offset:36864
    v_mfma_f32_16x16x32_bf16 v[124:127], v[72:75], v[28:31], v[124:127]
    s_waitcnt lgkmcnt(11)
    v_mfma_f32_16x16x32_bf16 v[140:143], v[76:79], v[28:31], v[140:143]
    ds_read_b64_tr_b16 v[64:65], v5 offset:13312
    v_mfma_f32_16x16x32_bf16 v[136:139], v[76:79], v[24:27], v[136:139]
    ds_read_b64_tr_b16 v[66:67], v5 offset:15104
    v_mfma_f32_16x16x32_bf16 v[132:135], v[76:79], v[20:23], v[132:135]
    ds_read_b128 v[44:47], v3 offset:38912
    v_mfma_f32_16x16x32_bf16 v[128:131], v[76:79], v[16:19], v[128:131]
    s_add_u32 m0, s54, 21504
    s_nop 0
    buffer_load_dwordx4 v12, s[36:39], s52 offen lds
    s_waitcnt lgkmcnt(12)
    v_mfma_f32_16x16x32_bf16 v[144:147], v[16:19], v[48:51], v[144:147]
    ds_read_b64_tr_b16 v[68:69], v5 offset:13344
    v_mfma_f32_16x16x32_bf16 v[148:151], v[20:23], v[48:51], v[148:151]
    ds_read_b64_tr_b16 v[70:71], v5 offset:15136
    v_mfma_f32_16x16x32_bf16 v[152:155], v[24:27], v[48:51], v[152:155]
    v_mfma_f32_16x16x32_bf16 v[156:159], v[28:31], v[48:51], v[156:159]
    s_waitcnt lgkmcnt(12)
    v_mfma_f32_16x16x32_bf16 v[172:175], v[28:31], v[52:55], v[172:175]
    s_add_u32 m0, s54, 22528
    s_nop 0
    buffer_load_dwordx4 v13, s[40:43], s52 offen lds
    s_add_u32 s52, s52, s53
    v_mfma_f32_16x16x32_bf16 v[168:171], v[24:27], v[52:55], v[168:171]
    v_mfma_f32_16x16x32_bf16 v[164:167], v[20:23], v[52:55], v[164:167]
    v_mfma_f32_16x16x32_bf16 v[160:163], v[16:19], v[52:55], v[160:163]
    s_waitcnt lgkmcnt(9)
    v_mfma_f32_16x16x32_bf16 v[176:179], v[56:59], v[16:19], v[176:179]
    v_mfma_f32_16x16x32_bf16 v[180:183], v[56:59], v[20:23], v[180:183]
    v_mfma_f32_16x16x32_bf16 v[184:187], v[56:59], v[24:27], v[184:187]
    v_mfma_f32_16x16x32_bf16 v[188:191], v[56:59], v[28:31], v[188:191]
    s_waitcnt vmcnt(9) lgkmcnt(0)
    s_barrier
    v_mfma_f32_16x16x32_bf16 v[204:207], v[60:63], v[28:31], v[204:207]
    ds_read_b64_tr_b16 v[72:73], v7 offset:20480
    v_mfma_f32_16x16x32_bf16 v[200:203], v[60:63], v[24:27], v[200:203]
    ds_read_b64_tr_b16 v[74:75], v7 offset:22016
    v_mfma_f32_16x16x32_bf16 v[196:199], v[60:63], v[20:23], v[196:199]
    ds_read_b64_tr_b16 v[76:77], v9 offset:20480
    v_mfma_f32_16x16x32_bf16 v[192:195], v[60:63], v[16:19], v[192:195]
    ds_read_b64_tr_b16 v[78:79], v9 offset:22016
    v_mfma_f32_16x16x32_bf16 v[208:211], v[64:67], v[16:19], v[208:211]
    ds_read_b64_tr_b16 v[48:49], v7 offset:20544
    v_mfma_f32_16x16x32_bf16 v[212:215], v[64:67], v[20:23], v[212:215]
    ds_read_b64_tr_b16 v[50:51], v7 offset:22080
    v_mfma_f32_16x16x32_bf16 v[216:219], v[64:67], v[24:27], v[216:219]
    ds_read_b64_tr_b16 v[52:53], v9 offset:20544
    v_mfma_f32_16x16x32_bf16 v[220:223], v[64:67], v[28:31], v[220:223]
    ds_read_b64_tr_b16 v[54:55], v9 offset:22080
    v_mfma_f32_16x16x32_bf16 v[236:239], v[68:71], v[28:31], v[236:239]
    ds_read_b64_tr_b16 v[56:57], v7 offset:20608
    v_mfma_f32_16x16x32_bf16 v[232:235], v[68:71], v[24:27], v[232:235]
    ds_read_b64_tr_b16 v[58:59], v7 offset:22144
    v_mfma_f32_16x16x32_bf16 v[228:231], v[68:71], v[20:23], v[228:231]
    v_mfma_f32_16x16x32_bf16 v[224:227], v[68:71], v[16:19], v[224:227]
    s_waitcnt lgkmcnt(8)
    v_mfma_f32_16x16x32_bf16 v[80:83], v[72:75], v[32:35], v[80:83]
    ds_read_b64_tr_b16 v[60:61], v9 offset:20608
    v_mfma_f32_16x16x32_bf16 v[84:87], v[72:75], v[36:39], v[84:87]
    ds_read_b64_tr_b16 v[62:63], v9 offset:22144
    v_mfma_f32_16x16x32_bf16 v[88:91], v[72:75], v[40:43], v[88:91]
    s_add_u32 m0, s56, 32768
    s_add_u32 s60, s55, 0
    buffer_load_dwordx4 v10, s[28:31], s60 offen lds
    v_mfma_f32_16x16x32_bf16 v[92:95], v[72:75], v[44:47], v[92:95]
    s_waitcnt lgkmcnt(8)
    v_mfma_f32_16x16x32_bf16 v[108:111], v[76:79], v[44:47], v[108:111]
    ds_read_b64_tr_b16 v[64:65], v5 offset:26624
    v_mfma_f32_16x16x32_bf16 v[104:107], v[76:79], v[40:43], v[104:107]
    ds_read_b64_tr_b16 v[66:67], v5 offset:28416
    v_mfma_f32_16x16x32_bf16 v[100:103], v[76:79], v[36:39], v[100:103]
    s_add_u32 m0, s56, 33792
    s_add_u32 s60, s55, 16384
    buffer_load_dwordx4 v10, s[28:31], s60 offen lds
    v_mfma_f32_16x16x32_bf16 v[96:99], v[76:79], v[32:35], v[96:99]
    s_waitcnt lgkmcnt(8)
    v_mfma_f32_16x16x32_bf16 v[112:115], v[48:51], v[32:35], v[112:115]
    ds_read_b64_tr_b16 v[68:69], v5 offset:26656
    v_mfma_f32_16x16x32_bf16 v[116:119], v[48:51], v[36:39], v[116:119]
    ds_read_b64_tr_b16 v[70:71], v5 offset:28448
    v_mfma_f32_16x16x32_bf16 v[120:123], v[48:51], v[40:43], v[120:123]
    s_add_u32 m0, s56, 34816
    s_add_u32 s60, s55, 32768
    buffer_load_dwordx4 v10, s[28:31], s60 offen lds
    s_add_u32 s55, s55, 128
    v_mfma_f32_16x16x32_bf16 v[124:127], v[48:51], v[44:47], v[124:127]
    s_waitcnt lgkmcnt(8)
    v_mfma_f32_16x16x32_bf16 v[140:143], v[52:55], v[44:47], v[140:143]
    ds_read_b64_tr_b16 v[72:73], v5 offset:33792
    v_mfma_f32_16x16x32_bf16 v[136:139], v[52:55], v[40:43], v[136:139]
    ds_read_b64_tr_b16 v[74:75], v5 offset:35584
    v_mfma_f32_16x16x32_bf16 v[132:135], v[52:55], v[36:39], v[132:135]
    s_add_u32 m0, s54, 40960
    s_nop 0
    buffer_load_dwordx4 v11, s[32:35], s52 offen lds
    v_mfma_f32_16x16x32_bf16 v[128:131], v[52:55], v[32:35], v[128:131]
    s_waitcnt lgkmcnt(8)
    v_mfma_f32_16x16x32_bf16 v[144:147], v[32:35], v[56:59], v[144:147]
    ds_read_b64_tr_b16 v[76:77], v5 offset:33824
    v_mfma_f32_16x16x32_bf16 v[148:151], v[36:39], v[56:59], v[148:151]
    ds_read_b64_tr_b16 v[78:79], v5 offset:35616
    v_mfma_f32_16x16x32_bf16 v[152:155], v[40:43], v[56:59], v[152:155]
    s_add_u32 m0, s54, 41984
    s_nop 0
    buffer_load_dwordx4 v12, s[36:39], s52 offen lds
    v_mfma_f32_16x16x32_bf16 v[156:159], v[44:47], v[56:59], v[156:159]
    s_waitcnt lgkmcnt(8)
    v_mfma_f32_16x16x32_bf16 v[172:175], v[44:47], v[60:63], v[172:175]
    s_add_u32 m0, s54, 43008
    s_nop 0
    buffer_load_dwordx4 v13, s[40:43], s52 offen lds
    s_add_u32 s52, s52, s53
    v_mfma_f32_16x16x32_bf16 v[168:171], v[40:43], v[60:63], v[168:171]
    v_mfma_f32_16x16x32_bf16 v[164:167], v[36:39], v[60:63], v[164:167]
    v_mfma_f32_16x16x32_bf16 v[160:163], v[32:35], v[60:63], v[160:163]
    s_waitcnt lgkmcnt(6)
    v_mfma_f32_16x16x32_bf16 v[176:179], v[64:67], v[32:35], v[176:179]
    v_mfma_f32_16x16x32_bf16 v[180:183], v[64:67], v[36:39], v[180:183]
    v_mfma_f32_16x16x32_bf16 v[184:187], v[64:67], v[40:43], v[184:187]
    v_mfma_f32_16x16x32_bf16 v[188:191], v[64:67], v[44:47], v[188:191]
    s_waitcnt vmcnt(9) lgkmcnt(0)
    s_barrier
    v_mfma_f32_16x16x32_bf16 v[204:207], v[68:71], v[44:47], v[204:207]
    ds_read_b64_tr_b16 v[48:49], v6 offset:0
    ds_read_b64_tr_b16 v[50:51], v6 offset:1536
    v_mfma_f32_16x16x32_bf16 v[200:203], v[68:71], v[40:43], v[200:203]
    ds_read_b128 v[16:19], v2 offset:0
    v_mfma_f32_16x16x32_bf16 v[196:199], v[68:71], v[36:39], v[196:199]
    ds_read_b128 v[20:23], v2 offset:2048
    v_mfma_f32_16x16x32_bf16 v[192:195], v[68:71], v[32:35], v[192:195]
    ds_read_b128 v[24:27], v2 offset:4096
    v_mfma_f32_16x16x32_bf16 v[208:211], v[72:75], v[32:35], v[208:211]
    ds_read_b128 v[28:31], v2 offset:6144
    ds_read_b64_tr_b16 v[52:53], v8 offset:0
    v_mfma_f32_16x16x32_bf16 v[212:215], v[72:75], v[36:39], v[212:215]
    ds_read_b64_tr_b16 v[54:55], v8 offset:1536
    v_mfma_f32_16x16x32_bf16 v[216:219], v[72:75], v[40:43], v[216:219]
    ds_read_b64_tr_b16 v[56:57], v6 offset:64
    v_mfma_f32_16x16x32_bf16 v[220:223], v[72:75], v[44:47], v[220:223]
    ds_read_b64_tr_b16 v[58:59], v6 offset:1600
    v_mfma_f32_16x16x32_bf16 v[236:239], v[76:79], v[44:47], v[236:239]
    ds_read_b64_tr_b16 v[60:61], v8 offset:64
    v_mfma_f32_16x16x32_bf16 v[232:235], v[76:79], v[40:43], v[232:235]
    ds_read_b64_tr_b16 v[62:63], v8 offset:1600
    v_mfma_f32_16x16x32_bf16 v[228:231], v[76:79], v[36:39], v[228:231]
    ds_read_b64_tr_b16 v[64:65], v6 offset:128
    v_mfma_f32_16x16x32_bf16 v[224:227], v[76:79], v[32:35], v[224:227]
    ds_read_b64_tr_b16 v[66:67], v6 offset:1664
    s_sub_u32 s57, s57, 1
    s_branch L_loop0
L_tail0:
    s_mov_b32 s52, 3216550459
    s_mov_b32 s54, 1.0
    s_mov_b32 s53, 3216550459
    s_mov_b32 s55, 1.0
    s_mul_i32 s27, s24, 24576
    s_add_u32 s27, s27, 262144
    s_add_u32 s27, s27, s26
    ds_read_b128 v[16:19], v2 offset:32768
    ds_read_b128 v[20:23], v2 offset:34816
    ds_read_b128 v[24:27], v2 offset:36864
    ds_read_b128 v[28:31], v2 offset:38912
    v_mfma_f32_16x16x32_bf16 v[192:195], v[52:55], v[32:35], v[192:195]
    ds_read_b64_tr_b16 v[64:65], v5 offset:6144
    ds_read_b64_tr_b16 v[66:67], v5 offset:7936
    v_mfma_f32_16x16x32_bf16 v[196:199], v[52:55], v[36:39], v[196:199]
    ds_read_b64_tr_b16 v[68:69], v5 offset:13312
    ds_read_b64_tr_b16 v[70:71], v5 offset:15104
    v_mfma_f32_16x16x32_bf16 v[200:203], v[52:55], v[40:43], v[200:203]
    ds_read_b64_tr_b16 v[72:73], v5 offset:26624
    ds_read_b64_tr_b16 v[74:75], v5 offset:28416
    v_mfma_f32_16x16x32_bf16 v[204:207], v[52:55], v[44:47], v[204:207]
    ds_read_b64_tr_b16 v[76:77], v5 offset:33792
    ds_read_b64_tr_b16 v[78:79], v5 offset:35584
    v_mfma_f32_16x16x32_bf16 v[220:223], v[56:59], v[44:47], v[220:223]
    v_mfma_f32_16x16x32_bf16 v[216:219], v[56:59], v[40:43], v[216:219]
    v_mfma_f32_16x16x32_bf16 v[212:215], v[56:59], v[36:39], v[212:215]
    ds_read_b64_tr_b16 v[48:49], v5 offset:6176
    ds_read_b64_tr_b16 v[50:51], v5 offset:7968
    v_mfma_f32_16x16x32_bf16 v[208:211], v[56:59], v[32:35], v[208:211]
    v_mfma_f32_16x16x32_bf16 v[224:227], v[60:63], v[32:35], v[224:227]
    v_mfma_f32_16x16x32_bf16 v[228:231], v[60:63], v[36:39], v[228:231]
    v_mfma_f32_16x16x32_bf16 v[232:235], v[60:63], v[40:43], v[232:235]
    ds_read_b64_tr_b16 v[52:53], v5 offset:13344
    ds_read_b64_tr_b16 v[54:55], v5 offset:15136
    v_mfma_f32_16x16x32_bf16 v[236:239], v[60:63], v[44:47], v[236:239]
    s_waitcnt lgkmcnt(10)
    v_mfma_f32_16x16x32_bf16 v[188:191], v[64:67], v[28:31], v[188:191]
    ds_read_b128 v[32:35], v3 offset:32768
    v_mfma_f32_16x16x32_bf16 v[184:187], v[64:67], v[24:27], v[184:187]
    ds_read_b128 v[36:39], v3 offset:34816
    v_mfma_f32_16x16x32_bf16 v[180:183], v[64:67], v[20:23], v[180:183]
    ds_read_b128 v[40:43], v3 offset:36864
    v_mfma_f32_16x16x32_bf16 v[176:179], v[64:67], v[16:19], v[176:179]
    ds_read_b128 v[44:47], v3 offset:38912
    s_waitcnt lgkmcnt(12)
    v_mfma_f32_16x16x32_bf16 v[208:211], v[68:71], v[16:19], v[208:211]
    ds_read_b64_tr_b16 v[56:57], v5 offset:26656
    ds_read_b64_tr_b16 v[58:59], v5 offset:28448
    v_mfma_f32_16x16x32_bf16 v[212:215], v[68:71], v[20:23], v[212:215]
    v_mfma_f32_16x16x32_bf16 v[216:219], v[68:71], v[24:27], v[216:219]
    v_mfma_f32_16x16x32_bf16 v[220:223], v[68:71], v[28:31], v[220:223]
    s_waitcnt lgkmcnt(2)
    v_mfma_f32_16x16x32_bf16 v[188:191], v[72:75], v[44:47], v[188:191]
    ds_read_b64_tr_b16 v[60:61], v5 offset:33824
    ds_read_b64_tr_b16 v[62:63], v5 offset:35616
    v_mfma_f32_16x16x32_bf16 v[184:187], v[72:75], v[40:43], v[184:187]
    v_mfma_f32_16x16x32_bf16 v[180:183], v[72:75], v[36:39], v[180:183]
    v_mfma_f32_16x16x32_bf16 v[176:179], v[72:75], v[32:35], v[176:179]
    v_mfma_f32_16x16x32_bf16 v[208:211], v[76:79], v[32:35], v[208:211]
    ds_read_b64_tr_b16 v[64:65], v7 offset:64
    ds_read_b64_tr_b16 v[66:67], v7 offset:1600
    v_mfma_f32_16x16x32_bf16 v[212:215], v[76:79], v[36:39], v[212:215]
    v_mfma_f32_16x16x32_bf16 v[216:219], v[76:79], v[40:43], v[216:219]
    v_mfma_f32_16x16x32_bf16 v[220:223], v[76:79], v[44:47], v[220:223]
    v_mfma_f32_16x16x32_bf16 v[204:207], v[48:51], v[28:31], v[204:207]
    ds_read_b64_tr_b16 v[68:69], v9 offset:64
    ds_read_b64_tr_b16 v[70:71], v9 offset:1600
    v_mfma_f32_16x16x32_bf16 v[200:203], v[48:51], v[24:27], v[200:203]
    v_mfma_f32_16x16x32_bf16 v[196:199], v[48:51], v[20:23], v[196:199]
    v_mul_f32 v176, v176, s52
    v_mul_f32 v177, v177, s53
    v_exp_f32 v176, v176
    v_mfma_f32_16x16x32_bf16 v[192:195], v[48:51], v[16:19], v[192:195]
    v_mul_f32 v178, v178, s52
    v_exp_f32 v177, v177
    v_mul_f32 v179, v179, s53
    v_mfma_f32_16x16x32_bf16 v[224:227], v[52:55], v[16:19], v[224:227]
    ds_read_b64_tr_b16 v[72:73], v7 offset:20544
    ds_read_b64_tr_b16 v[74:75], v7 offset:22080
    v_exp_f32 v178, v178
    v_mul_f32 v180, v180, s52
    v_exp_f32 v179, v179
    v_mfma_f32_16x16x32_bf16 v[228:231], v[52:55], v[20:23], v[228:231]
    v_mul_f32 v181, v181, s53
    v_exp_f32 v180, v180
    v_mul_f32 v182, v182, s52
    v_mfma_f32_16x16x32_bf16 v[232:235], v[52:55], v[24:27], v[232:235]
    v_exp_f32 v181, v181
    v_mul_f32 v183, v183, s53
    v_exp_f32 v182, v182
    v_mfma_f32_16x16x32_bf16 v[236:239], v[52:55], v[28:31], v[236:239]
    v_mul_f32 v184, v184, s52
    v_exp_f32 v183, v183
    v_mul_f32 v185, v185, s53
    s_waitcnt lgkmcnt(8)
    v_mfma_f32_16x16x32_bf16 v[204:207], v[56:59], v[44:47], v[204:207]
    ds_read_b64_tr_b16 v[76:77], v9 offset:20544
    ds_read_b64_tr_b16 v[78:79], v9 offset:22080
    v_exp_f32 v184, v184
    v_mul_f32 v186, v186, s52
    v_exp_f32 v185, v185
    v_mfma_f32_16x16x32_bf16 v[200:203], v[56:59], v[40:43], v[200:203]
    v_mul_f32 v187, v187, s53
    v_exp_f32 v186, v186
    v_mul_f32 v188, v188, s52
    v_mfma_f32_16x16x32_bf16 v[196:199], v[56:59], v[36:39], v[196:199]
    v_exp_f32 v187, v187
    v_mul_f32 v189, v189, s53
    v_exp_f32 v188, v188
    v_mfma_f32_16x16x32_bf16 v[192:195], v[56:59], v[32:35], v[192:195]
    v_mul_f32 v190, v190, s52
    v_exp_f32 v189, v189
    v_mul_f32 v191, v191, s53
    s_waitcnt lgkmcnt(8)
    v_mfma_f32_16x16x32_bf16 v[224:227], v[60:63], v[32:35], v[224:227]
    ds_read_b64_tr_b16 v[48:49], v7 offset:128
    ds_read_b64_tr_b16 v[50:51], v7 offset:1664
    v_exp_f32 v190, v190
    v_add_f32 v176, v176, s54
    v_exp_f32 v191, v191
    v_mfma_f32_16x16x32_bf16 v[228:231], v[60:63], v[36:39], v[228:231]
    v_add_f32 v177, v177, s55
    v_rcp_f32 v176, v176
    v_add_f32 v178, v178, s54
    v_mfma_f32_16x16x32_bf16 v[232:235], v[60:63], v[40:43], v[232:235]
    v_rcp_f32 v177, v177
    v_add_f32 v179, v179, s55
    v_rcp_f32 v178, v178
    v_mfma_f32_16x16x32_bf16 v[236:239], v[60:63], v[44:47], v[236:239]
    v_add_f32 v180, v180, s54
    v_rcp_f32 v179, v179
    v_add_f32 v181, v181, s55
    s_waitcnt lgkmcnt(8)
    v_mfma_f32_16x16x32_bf16 v[124:127], v[64:67], v[28:31], v[124:127]
    ds_read_b64_tr_b16 v[52:53], v9 offset:128
    ds_read_b64_tr_b16 v[54:55], v9 offset:1664
    v_rcp_f32 v180, v180
    v_add_f32 v182, v182, s54
    v_rcp_f32 v181, v181
    v_mfma_f32_16x16x32_bf16 v[120:123], v[64:67], v[24:27], v[120:123]
    v_add_f32 v183, v183, s55
    v_rcp_f32 v182, v182
    v_add_f32 v184, v184, s54
    v_mfma_f32_16x16x32_bf16 v[116:119], v[64:67], v[20:23], v[116:119]
    v_rcp_f32 v183, v183
    v_add_f32 v185, v185, s55
    v_rcp_f32 v184, v184
    v_mfma_f32_16x16x32_bf16 v[112:115], v[64:67], v[16:19], v[112:115]
    v_add_f32 v186, v186, s54
    v_rcp_f32 v185, v185
    v_add_f32 v187, v187, s55
    s_waitcnt lgkmcnt(8)
    v_mfma_f32_16x16x32_bf16 v[128:131], v[68:71], v[16:19], v[128:131]
    ds_read_b64_tr_b16 v[56:57], v7 offset:20608
    ds_read_b64_tr_b16 v[58:59], v7 offset:22144
    v_rcp_f32 v186, v186
    v_add_f32 v188, v188, s54
    v_rcp_f32 v187, v187
    v_mfma_f32_16x16x32_bf16 v[132:135], v[68:71], v[20:23], v[132:135]
    v_add_f32 v189, v189, s55
    v_rcp_f32 v188, v188
    v_add_f32 v190, v190, s54
    v_mfma_f32_16x16x32_bf16 v[136:139], v[68:71], v[24:27], v[136:139]
    v_rcp_f32 v189, v189
    v_add_f32 v191, v191, s55
    v_rcp_f32 v190, v190
    v_mfma_f32_16x16x32_bf16 v[140:143], v[68:71], v[28:31], v[140:143]
    v_mul_f32 v208, v208, v176
    v_rcp_f32 v191, v191
    v_mul_f32 v209, v209, v177
    s_waitcnt lgkmcnt(8)
    v_mfma_f32_16x16x32_bf16 v[124:127], v[72:75], v[44:47], v[124:127]
    ds_read_b64_tr_b16 v[60:61], v9 offset:20608
    ds_read_b64_tr_b16 v[62:63], v9 offset:22144
    v_mul_f32 v210, v210, v178
    v_mul_f32 v211, v211, v179
    v_mul_f32 v212, v212, v180
    v_mfma_f32_16x16x32_bf16 v[120:123], v[72:75], v[40:43], v[120:123]
    v_mul_f32 v213, v213, v181
    v_mul_f32 v214, v214, v182
    v_mul_f32 v215, v215, v183
    v_mfma_f32_16x16x32_bf16 v[116:119], v[72:75], v[36:39], v[116:119]
    v_mul_f32 v216, v216, v184
    v_mul_f32 v217, v217, v185
    v_mul_f32 v218, v218, v186
    v_mfma_f32_16x16x32_bf16 v[112:115], v[72:75], v[32:35], v[112:115]
    v_mul_f32 v219, v219, v187
    v_mul_f32 v220, v220, v188
    v_mul_f32 v221, v221, v189
    s_waitcnt lgkmcnt(8)
    v_mfma_f32_16x16x32_bf16 v[128:131], v[76:79], v[32:35], v[128:131]
    ds_read_b64_tr_b16 v[64:65], v7 offset:0
    ds_read_b64_tr_b16 v[66:67], v7 offset:1536
    v_mul_f32 v222, v222, v190
    v_mul_f32 v223, v223, v191
    v_mul_f32 v192, v192, s52
    v_mfma_f32_16x16x32_bf16 v[132:135], v[76:79], v[36:39], v[132:135]
    v_mul_f32 v193, v193, s53
    v_exp_f32 v192, v192
    v_mul_f32 v194, v194, s52
    v_mfma_f32_16x16x32_bf16 v[136:139], v[76:79], v[40:43], v[136:139]
    v_exp_f32 v193, v193
    v_mul_f32 v195, v195, s53
    v_exp_f32 v194, v194
    v_mfma_f32_16x16x32_bf16 v[140:143], v[76:79], v[44:47], v[140:143]
    v_mul_f32 v196, v196, s52
    v_exp_f32 v195, v195
    v_mul_f32 v197, v197, s53
    s_waitcnt lgkmcnt(8)
    v_mfma_f32_16x16x32_bf16 v[156:159], v[28:31], v[48:51], v[156:159]
    ds_read_b64_tr_b16 v[68:69], v9 offset:0
    ds_read_b64_tr_b16 v[70:71], v9 offset:1536
    v_exp_f32 v196, v196
    v_mul_f32 v198, v198, s52
    v_exp_f32 v197, v197
    v_mfma_f32_16x16x32_bf16 v[152:155], v[24:27], v[48:51], v[152:155]
    v_mul_f32 v199, v199, s53
    v_exp_f32 v198, v198
    v_mul_f32 v200, v200, s52
    v_mfma_f32_16x16x32_bf16 v[148:151], v[20:23], v[48:51], v[148:151]
    v_exp_f32 v199, v199
    v_mul_f32 v201, v201, s53
    v_exp_f32 v200, v200
    v_mfma_f32_16x16x32_bf16 v[144:147], v[16:19], v[48:51], v[144:147]
    v_mul_f32 v202, v202, s52
    v_exp_f32 v201, v201
    v_mul_f32 v203, v203, s53
    s_waitcnt lgkmcnt(8)
    v_mfma_f32_16x16x32_bf16 v[160:163], v[16:19], v[52:55], v[160:163]
    ds_read_b64_tr_b16 v[72:73], v7 offset:20480
    ds_read_b64_tr_b16 v[74:75], v7 offset:22016
    v_exp_f32 v202, v202
    v_mul_f32 v204, v204, s52
    v_exp_f32 v203, v203
    v_mfma_f32_16x16x32_bf16 v[164:167], v[20:23], v[52:55], v[164:167]
    v_mul_f32 v205, v205, s53
    v_exp_f32 v204, v204
    v_mul_f32 v206, v206, s52
    v_mfma_f32_16x16x32_bf16 v[168:171], v[24:27], v[52:55], v[168:171]
    v_exp_f32 v205, v205
    v_mul_f32 v207, v207, s53
    v_exp_f32 v206, v206
    v_mfma_f32_16x16x32_bf16 v[172:175], v[28:31], v[52:55], v[172:175]
    v_add_f32 v192, v192, s54
    v_exp_f32 v207, v207
    v_add_f32 v193, v193, s55
    s_waitcnt lgkmcnt(8)
    v_mfma_f32_16x16x32_bf16 v[156:159], v[44:47], v[56:59], v[156:159]
    ds_read_b64_tr_b16 v[76:77], v9 offset:20480
    ds_read_b64_tr_b16 v[78:79], v9 offset:22016
    v_rcp_f32 v192, v192
    v_add_f32 v194, v194, s54
    v_rcp_f32 v193, v193
    v_mfma_f32_16x16x32_bf16 v[152:155], v[40:43], v[56:59], v[152:155]
    v_add_f32 v195, v195, s55
    v_rcp_f32 v194, v194
    v_add_f32 v196, v196, s54
    v_mfma_f32_16x16x32_bf16 v[148:151], v[36:39], v[56:59], v[148:151]
    v_rcp_f32 v195, v195
    v_add_f32 v197, v197, s55
    v_rcp_f32 v196, v196
    v_mfma_f32_16x16x32_bf16 v[144:147], v[32:35], v[56:59], v[144:147]
    v_add_f32 v198, v198, s54
    v_rcp_f32 v197, v197
    v_add_f32 v199, v199, s55
    s_waitcnt lgkmcnt(8)
    v_mfma_f32_16x16x32_bf16 v[160:163], v[32:35], v[60:63], v[160:163]
    v_rcp_f32 v198, v198
    v_add_f32 v200, v200, s54
    v_rcp_f32 v199, v199
    v_mfma_f32_16x16x32_bf16 v[164:167], v[36:39], v[60:63], v[164:167]
    v_add_f32 v201, v201, s55
    v_rcp_f32 v200, v200
    v_add_f32 v202, v202, s54
    v_mfma_f32_16x16x32_bf16 v[168:171], v[40:43], v[60:63], v[168:171]
    v_rcp_f32 v201, v201
    v_add_f32 v203, v203, s55
    v_rcp_f32 v202, v202
    v_mfma_f32_16x16x32_bf16 v[172:175], v[44:47], v[60:63], v[172:175]
    v_add_f32 v204, v204, s54
    v_rcp_f32 v203, v203
    v_add_f32 v205, v205, s55
    s_waitcnt lgkmcnt(6)
    v_mfma_f32_16x16x32_bf16 v[92:95], v[64:67], v[28:31], v[92:95]
    v_rcp_f32 v204, v204
    v_add_f32 v206, v206, s54
    v_rcp_f32 v205, v205
    v_mfma_f32_16x16x32_bf16 v[88:91], v[64:67], v[24:27], v[88:91]
    v_add_f32 v207, v207, s55
    v_rcp_f32 v206, v206
    v_mul_f32 v224, v224, v192
    v_mfma_f32_16x16x32_bf16 v[84:87], v[64:67], v[20:23], v[84:87]
    v_rcp_f32 v207, v207
    v_mul_f32 v225, v225, v193
    v_mul_f32 v226, v226, v194
    v_mfma_f32_16x16x32_bf16 v[80:83], v[64:67], v[16:19], v[80:83]
    v_mul_f32 v227, v227, v195
    v_mul_f32 v228, v228, v196
    v_mul_f32 v229, v229, v197
    s_waitcnt lgkmcnt(4)
    v_mfma_f32_16x16x32_bf16 v[96:99], v[68:71], v[16:19], v[96:99]
    v_mul_f32 v230, v230, v198
    v_mul_f32 v231, v231, v199
    v_mul_f32 v232, v232, v200
    v_mfma_f32_16x16x32_bf16 v[100:103], v[68:71], v[20:23], v[100:103]
    v_mul_f32 v233, v233, v201
    v_mul_f32 v234, v234, v202
    v_mul_f32 v235, v235, v203
    v_mfma_f32_16x16x32_bf16 v[104:107], v[68:71], v[24:27], v[104:107]
    v_mul_f32 v236, v236, v204
    v_mul_f32 v237, v237, v205
    v_mul_f32 v238, v238, v206
    v_mfma_f32_16x16x32_bf16 v[108:111], v[68:71], v[28:31], v[108:111]
    v_mul_f32 v239, v239, v207
    v_cvt_pk_bf16_f32 v176, v208, v209
    v_cvt_pk_bf16_f32 v177, v210, v211
    s_waitcnt lgkmcnt(2)
    v_mfma_f32_16x16x32_bf16 v[92:95], v[72:75], v[44:47], v[92:95]
    v_cvt_pk_bf16_f32 v178, v224, v225
    v_cvt_pk_bf16_f32 v179, v226, v227
    buffer_store_dwordx4 v[176:179], v15, s[44:47], s27 offen offset:0
    v_mfma_f32_16x16x32_bf16 v[88:91], v[72:75], v[40:43], v[88:91]
    v_cvt_pk_bf16_f32 v180, v212, v213
    v_cvt_pk_bf16_f32 v181, v214, v215
    v_cvt_pk_bf16_f32 v182, v228, v229
    v_mfma_f32_16x16x32_bf16 v[84:87], v[72:75], v[36:39], v[84:87]
    v_cvt_pk_bf16_f32 v183, v230, v231
    buffer_store_dwordx4 v[180:183], v15, s[44:47], s27 offen offset:1024
    v_cvt_pk_bf16_f32 v184, v216, v217
    v_mfma_f32_16x16x32_bf16 v[80:83], v[72:75], v[32:35], v[80:83]
    v_cvt_pk_bf16_f32 v185, v218, v219
    v_cvt_pk_bf16_f32 v186, v232, v233
    v_cvt_pk_bf16_f32 v187, v234, v235
    s_waitcnt lgkmcnt(0)
    v_mfma_f32_16x16x32_bf16 v[96:99], v[76:79], v[32:35], v[96:99]
    buffer_store_dwordx4 v[184:187], v15, s[44:47], s27 offen offset:2048
    v_cvt_pk_bf16_f32 v188, v220, v221
    v_cvt_pk_bf16_f32 v189, v222, v223
    v_mfma_f32_16x16x32_bf16 v[100:103], v[76:79], v[36:39], v[100:103]
    v_cvt_pk_bf16_f32 v190, v236, v237
    v_cvt_pk_bf16_f32 v191, v238, v239
    buffer_store_dwordx4 v[188:191], v15, s[44:47], s27 offen offset:3072
    v_mfma_f32_16x16x32_bf16 v[104:107], v[76:79], v[40:43], v[104:107]
    v_cvt_pk_bf16_f32 v144, v144, v145
    v_cvt_pk_bf16_f32 v145, v146, v147
    v_cvt_pk_bf16_f32 v146, v148, v149
    v_mfma_f32_16x16x32_bf16 v[108:111], v[76:79], v[44:47], v[108:111]
    v_cvt_pk_bf16_f32 v147, v150, v151
    v_cvt_pk_bf16_f32 v152, v152, v153
    v_cvt_pk_bf16_f32 v153, v154, v155
    s_barrier
    v_cvt_pk_bf16_f32 v154, v156, v157
    v_cvt_pk_bf16_f32 v155, v158, v159
    v_cvt_pk_bf16_f32 v160, v160, v161
    v_cvt_pk_bf16_f32 v161, v162, v163
    v_cvt_pk_bf16_f32 v162, v164, v165
    v_cvt_pk_bf16_f32 v163, v166, v167
    v_cvt_pk_bf16_f32 v168, v168, v169
    v_cvt_pk_bf16_f32 v169, v170, v171
    v_cvt_pk_bf16_f32 v170, v172, v173
    v_cvt_pk_bf16_f32 v171, v174, v175
    s_nop 7
    s_setprio 2
    s_mov_b32 s52, 3216550459
    s_mov_b32 s54, 1.0
    s_mov_b32 s53, 3216550459
    s_mov_b32 s55, 1.0
    v_lshlrev_b32 v2, 4, v1
    s_mov_b32 s69, 0x40000
    s_waitcnt vmcnt(11)
L_tag0:
    v_cmp_eq_u32 vcc, 0, v247
    s_cbranch_vccz L_tag0_go
    s_sub_u32 s69, s69, 1
    s_cbranch_scc1 L_tag0_go
    buffer_load_ubyte v247, v248, s[4:7], 0 offen sc1
    s_waitcnt vmcnt(0)
    s_branch L_tag0
L_tag0_go:
    v_cmp_ne_u32 vcc, s82, v247
    s_lshl_b32 s60, s84, 3
    s_lshr_b32 s60, vcc_lo, s60
    s_and_b32 s60, s60, 0xff
    s_cselect_b32 s83, 0, 1
    s_waitcnt lgkmcnt(0)
    s_setprio 0
    s_lshl_b32 s60, s22, 12
    v_lshrrev_b32 v3, 2, v1
    s_add_u32 s61, s60, 131072
    s_mov_b64 s[36:37], s[72:73]
    s_mov_b32 s38, 7340032
    s_mov_b64 s[76:77], s[10:11]
    s_mov_b32 s78, 2097152
    s_mov_b64 s[40:41], s[80:81]
    s_mov_b32 s42, 4194304
    s_mov_b64 s[48:49], s[74:75]
    s_and_b32 s64, s20, 1
    v_cvt_pk_bf16_f32 v80, v80, v81
    v_lshlrev_b32 v3, 6, v3
    v_and_b32 v4, 3, v1
    v_cvt_pk_bf16_f32 v81, v82, v83
    v_cvt_pk_bf16_f32 v84, v84, v85
    v_lshrrev_b32 v14, 4, v1
    s_lshl_b32 s64, s64, 3
    v_add_u32 v10, s61, v2
    v_cvt_pk_bf16_f32 v82, v96, v97
    v_cvt_pk_bf16_f32 v83, v98, v99
    v_cvt_pk_bf16_f32 v85, v86, v87
    v_cvt_pk_bf16_f32 v88, v88, v89
    v_cvt_pk_bf16_f32 v86, v100, v101
    v_cvt_pk_bf16_f32 v87, v102, v103
    v_cvt_pk_bf16_f32 v89, v90, v91
    v_cvt_pk_bf16_f32 v92, v92, v93
    v_lshl_add_u32 v3, v4, 3, v3
    v_cvt_pk_bf16_f32 v90, v104, v105
    v_cvt_pk_bf16_f32 v91, v106, v107
    v_cvt_pk_bf16_f32 v93, v94, v95
    v_and_b32 v12, 15, v1
    v_lshl_or_b32 v13, v14, 1, s64
    ds_write_b128 v10, v[80:83] offset:0
    v_cvt_pk_bf16_f32 v94, v108, v109
    v_cvt_pk_bf16_f32 v95, v110, v111
    ds_write_b128 v10, v[84:87] offset:1024
    v_add_u32 v3, 147456, v3
    ds_write_b128 v10, v[88:91] offset:2048
    v_xor_b32 v12, v12, v13
    ds_write_b128 v10, v[92:95] offset:3072
    ds_read_b64_tr_b16 v[96:97], v3 offset:0
    v_add_u32 v11, s60, v2
    ds_read_b64_tr_b16 v[98:99], v3 offset:1024
    v_lshlrev_b32 v12, 4, v12
    ds_read_b64_tr_b16 v[100:101], v3 offset:32
    ds_read_b64_tr_b16 v[102:103], v3 offset:1056
    v_lshl_add_u32 v12, v14, 11, v12
    s_lshl_b32 s65, s85, 8
    ds_write_b128 v11, v[144:147] offset:32768
    ds_write_b128 v11, v[152:155] offset:34816
    ds_write_b128 v11, v[160:163] offset:33792
    v_add_u32 v13, s65, v12
    ds_write_b128 v11, v[168:171] offset:35840
    s_add_u32 m0, s91, 0
    s_add_u32 s62, s86, 0
    buffer_load_dwordx4 v13, s[36:39], s62 offen lds
    s_add_u32 m0, s91, 8192
    s_add_u32 s62, s86, 65536
    buffer_load_dwordx4 v13, s[36:39], s62 offen lds
    s_add_u32 m0, s91, 16384
    s_add_u32 s62, s86, 131072
    buffer_load_dwordx4 v13, s[36:39], s62 offen lds
    s_add_u32 m0, s91, 24576
    s_add_u32 s62, s86, 229376
    buffer_load_dwordx4 v13, s[36:39], s62 offen lds
    s_add_u32 m0, s91, 32768
    s_add_u32 s62, s86, 294912
    buffer_load_dwordx4 v13, s[36:39], s62 offen lds
    s_add_u32 m0, s91, 40960
    s_add_u32 s62, s86, 360448
    buffer_load_dwordx4 v13, s[36:39], s62 offen lds
    s_waitcnt lgkmcnt(0)
    v_cvt_pk_bf16_f32 v16, v112, v113
    v_cvt_pk_bf16_f32 v17, v114, v115
    v_cvt_pk_bf16_f32 v18, v128, v129
    v_cvt_pk_bf16_f32 v19, v130, v131
    v_cvt_pk_bf16_f32 v20, v116, v117
    v_cvt_pk_bf16_f32 v21, v118, v119
    v_mfma_f32_16x16x32_bf16 v[112:115], v[96:99], v[16:19], 0
    v_cvt_pk_bf16_f32 v22, v132, v133
    v_cvt_pk_bf16_f32 v23, v134, v135
    v_cvt_pk_bf16_f32 v24, v120, v121
    v_mfma_f32_16x16x32_bf16 v[128:131], v[100:103], v[16:19], 0
    v_cvt_pk_bf16_f32 v25, v122, v123
    v_cvt_pk_bf16_f32 v26, v136, v137
    v_cvt_pk_bf16_f32 v27, v138, v139
    v_mfma_f32_16x16x32_bf16 v[116:119], v[96:99], v[20:23], 0
    v_cvt_pk_bf16_f32 v28, v124, v125
    v_cvt_pk_bf16_f32 v29, v126, v127
    v_cvt_pk_bf16_f32 v30, v140, v141
    v_mfma_f32_16x16x32_bf16 v[120:123], v[96:99], v[24:27], 0
    v_cvt_pk_bf16_f32 v31, v142, v143
    v_min3_f32 v56, v112, v113, v114
    v_max3_f32 v48, v112, v113, v114
    v_mfma_f32_16x16x32_bf16 v[124:127], v[96:99], v[28:31], 0
    v_min3_f32 v56, v56, v115, v128
    v_max3_f32 v48, v48, v115, v128
    v_min3_f32 v56, v56, v129, v130
    v_mfma_f32_16x16x32_bf16 v[132:135], v[100:103], v[20:23], 0
    v_min3_f32 v58, v116, v117, v118
    v_max3_f32 v50, v116, v117, v118
    v_max3_f32 v48, v48, v129, v130
    v_mfma_f32_16x16x32_bf16 v[136:139], v[100:103], v[24:27], 0
    v_min3_f32 v60, v120, v121, v122
    v_max3_f32 v52, v120, v121, v122
    v_min_f32 v56, v56, v131
    v_mfma_f32_16x16x32_bf16 v[140:143], v[100:103], v[28:31], 0
    v_min3_f32 v62, v124, v125, v126
    v_max3_f32 v54, v124, v125, v126
    v_max_f32 v48, v48, v131
    v_min3_f32 v58, v58, v119, v132
    v_max3_f32 v50, v50, v119, v132
    v_min3_f32 v58, v58, v133, v134
    v_max3_f32 v50, v50, v133, v134
    v_min3_f32 v60, v60, v123, v136
    v_max3_f32 v52, v52, v123, v136
    v_min3_f32 v60, v60, v137, v138
    v_max3_f32 v52, v52, v137, v138
    v_min3_f32 v62, v62, v127, v140
    v_max3_f32 v54, v54, v127, v140
    v_min3_f32 v62, v62, v141, v142
    v_max3_f32 v54, v54, v141, v142
    v_min_f32 v58, v58, v135
    v_min_f32 v60, v60, v139
    v_min_f32 v62, v62, v143
    v_permlane16_swap_b32 v56, v58
    v_max_f32 v50, v50, v135
    v_permlane16_swap_b32 v60, v62
    v_max_f32 v52, v52, v139
    v_permlane16_swap_b32 v48, v50
    v_max_f32 v54, v54, v143
    v_min_f32 v56, v56, v58
    v_min_f32 v60, v60, v62
    v_permlane16_swap_b32 v52, v54
    v_max_f32 v48, v48, v50
    v_permlane32_swap_b32 v56, v60
    v_max_f32 v52, v52, v54
    v_min_f32 v56, v56, v60
    s_lshl_b32 s60, s22, 13
    v_permlane32_swap_b32 v48, v52
    v_mul_f32 v56, s58, v56
    v_max_f32 v48, v48, v52
    v_mov_b32 v60, v56
    v_mul_f32 v48, s58, v48
    s_add_u32 s64, s84, 0
    v_permlane32_swap_b32 v56, v60
    v_mov_b32 v52, v48
    v_mov_b32 v58, v56
    v_mov_b32 v62, v60
    v_permlane32_swap_b32 v48, v52
    v_lshrrev_b32 v4, 4, v1
    v_permlane16_swap_b32 v56, v58
    v_mov_b32 v50, v48
    v_permlane16_swap_b32 v60, v62
    v_mov_b32 v54, v52
    v_permlane16_swap_b32 v48, v50
    v_mov_b32 v57, v56
    v_permlane16_swap_b32 v52, v54
    v_mov_b32 v59, v58
    v_mov_b32 v61, v60
    v_mov_b32 v63, v62
    v_mov_b32 v49, v48
    v_mov_b32 v51, v50
    v_mov_b32 v53, v52
    v_mov_b32 v55, v54
    v_pk_fma_f32 v[16:17], v[112:113], s[58:59], v[56:57] neg_lo:[1,0,0] neg_hi:[1,0,0]
    v_pk_fma_f32 v[18:19], v[114:115], s[58:59], v[56:57] neg_lo:[1,0,0] neg_hi:[1,0,0]
    v_exp_f32 v16, v16
    v_pk_fma_f32 v[24:25], v[116:117], s[58:59], v[58:59] neg_lo:[1,0,0] neg_hi:[1,0,0]
    v_exp_f32 v17, v17
    v_pk_fma_f32 v[26:27], v[118:119], s[58:59], v[58:59] neg_lo:[1,0,0] neg_hi:[1,0,0]
    v_exp_f32 v18, v18
    v_pk_fma_f32 v[32:33], v[120:121], s[58:59], v[60:61] neg_lo:[1,0,0] neg_hi:[1,0,0]
    v_exp_f32 v19, v19
    v_pk_fma_f32 v[34:35], v[122:123], s[58:59], v[60:61] neg_lo:[1,0,0] neg_hi:[1,0,0]
    v_exp_f32 v24, v24
    v_pk_fma_f32 v[40:41], v[124:125], s[58:59], v[62:63] neg_lo:[1,0,0] neg_hi:[1,0,0]
    v_exp_f32 v25, v25
    v_pk_fma_f32 v[42:43], v[126:127], s[58:59], v[62:63] neg_lo:[1,0,0] neg_hi:[1,0,0]
    v_exp_f32 v26, v26
    v_pk_fma_f32 v[112:113], v[112:113], s[58:59], v[48:49] neg_lo:[0,0,1] neg_hi:[0,0,1]
    v_exp_f32 v27, v27
    v_pk_fma_f32 v[114:115], v[114:115], s[58:59], v[48:49] neg_lo:[0,0,1] neg_hi:[0,0,1]
    v_exp_f32 v112, v112
    v_pk_fma_f32 v[116:117], v[116:117], s[58:59], v[50:51] neg_lo:[0,0,1] neg_hi:[0,0,1]
    v_exp_f32 v113, v113
    v_pk_fma_f32 v[118:119], v[118:119], s[58:59], v[50:51] neg_lo:[0,0,1] neg_hi:[0,0,1]
    v_exp_f32 v114, v114
    v_pk_fma_f32 v[120:121], v[120:121], s[58:59], v[52:53] neg_lo:[0,0,1] neg_hi:[0,0,1]
    v_exp_f32 v115, v115
    v_pk_fma_f32 v[122:123], v[122:123], s[58:59], v[52:53] neg_lo:[0,0,1] neg_hi:[0,0,1]
    v_exp_f32 v116, v116
    v_pk_fma_f32 v[124:125], v[124:125], s[58:59], v[54:55] neg_lo:[0,0,1] neg_hi:[0,0,1]
    v_exp_f32 v117, v117
    v_pk_fma_f32 v[126:127], v[126:127], s[58:59], v[54:55] neg_lo:[0,0,1] neg_hi:[0,0,1]
    v_exp_f32 v118, v118
    v_pk_fma_f32 v[20:21], v[128:129], s[58:59], v[56:57] neg_lo:[1,0,0] neg_hi:[1,0,0]
    v_exp_f32 v119, v119
    v_pk_fma_f32 v[28:29], v[132:133], s[58:59], v[58:59] neg_lo:[1,0,0] neg_hi:[1,0,0]
    v_exp_f32 v120, v120
    v_pk_fma_f32 v[36:37], v[136:137], s[58:59], v[60:61] neg_lo:[1,0,0] neg_hi:[1,0,0]
    v_exp_f32 v121, v121
    v_pk_fma_f32 v[44:45], v[140:141], s[58:59], v[62:63] neg_lo:[1,0,0] neg_hi:[1,0,0]
    v_exp_f32 v122, v122
    v_pk_fma_f32 v[128:129], v[128:129], s[58:59], v[48:49] neg_lo:[0,0,1] neg_hi:[0,0,1]
    v_exp_f32 v123, v123
    v_pk_fma_f32 v[132:133], v[132:133], s[58:59], v[50:51] neg_lo:[0,0,1] neg_hi:[0,0,1]
    v_exp_f32 v124, v124
    v_pk_fma_f32 v[136:137], v[136:137], s[58:59], v[52:53] neg_lo:[0,0,1] neg_hi:[0,0,1]
    v_exp_f32 v125, v125
    v_pk_fma_f32 v[140:141], v[140:141], s[58:59], v[54:55] neg_lo:[0,0,1] neg_hi:[0,0,1]
    v_exp_f32 v126, v126
    v_pk_fma_f32 v[22:23], v[130:131], s[58:59], v[56:57] neg_lo:[1,0,0] neg_hi:[1,0,0]
    v_exp_f32 v127, v127
    v_pk_fma_f32 v[30:31], v[134:135], s[58:59], v[58:59] neg_lo:[1,0,0] neg_hi:[1,0,0]
    v_exp_f32 v32, v32
    v_pk_fma_f32 v[38:39], v[138:139], s[58:59], v[60:61] neg_lo:[1,0,0] neg_hi:[1,0,0]
    v_exp_f32 v33, v33
    v_pk_fma_f32 v[46:47], v[142:143], s[58:59], v[62:63] neg_lo:[1,0,0] neg_hi:[1,0,0]
    v_exp_f32 v34, v34
    v_pk_fma_f32 v[130:131], v[130:131], s[58:59], v[48:49] neg_lo:[0,0,1] neg_hi:[0,0,1]
    v_exp_f32 v35, v35
    v_pk_fma_f32 v[134:135], v[134:135], s[58:59], v[50:51] neg_lo:[0,0,1] neg_hi:[0,0,1]
    v_exp_f32 v40, v40
    v_pk_fma_f32 v[138:139], v[138:139], s[58:59], v[52:53] neg_lo:[0,0,1] neg_hi:[0,0,1]
    v_exp_f32 v41, v41
    v_pk_fma_f32 v[142:143], v[142:143], s[58:59], v[54:55] neg_lo:[0,0,1] neg_hi:[0,0,1]
    v_exp_f32 v42, v42
    v_pk_add_f32 v[48:49], v[112:113], v[114:115]
    v_exp_f32 v43, v43
    v_pk_add_f32 v[50:51], v[116:117], v[118:119]
    v_exp_f32 v128, v128
    v_pk_add_f32 v[52:53], v[120:121], v[122:123]
    v_exp_f32 v129, v129
    v_pk_add_f32 v[54:55], v[124:125], v[126:127]
    v_exp_f32 v132, v132
    v_pk_add_f32 v[56:57], v[16:17], v[18:19]
    v_exp_f32 v133, v133
    v_pk_add_f32 v[58:59], v[24:25], v[26:27]
    v_exp_f32 v136, v136
    v_pk_add_f32 v[60:61], v[32:33], v[34:35]
    v_exp_f32 v137, v137
    v_pk_add_f32 v[62:63], v[40:41], v[42:43]
    v_exp_f32 v140, v140
    v_pk_add_f32 v[48:49], v[48:49], v[128:129]
    v_exp_f32 v141, v141
    v_pk_add_f32 v[50:51], v[50:51], v[132:133]
    v_exp_f32 v20, v20
    v_pk_add_f32 v[52:53], v[52:53], v[136:137]
    v_exp_f32 v21, v21
    v_pk_add_f32 v[54:55], v[54:55], v[140:141]
    v_exp_f32 v28, v28
    s_and_b32 s64, s64, 3
    v_exp_f32 v29, v29
    s_waitcnt vmcnt(6)
    s_barrier
    v_and_b32 v252, 7, v1
    s_andn2_b32 s68, s3, 0x380
    s_add_u32 s68, s68, 0x8000
    v_lshl_add_u32 v252, v252, 7, s68
    v_pk_add_f32 v[56:57], v[56:57], v[20:21]
    v_exp_f32 v36, v36
    v_lshlrev_b32 v5, 10, v4
    v_exp_f32 v37, v37
    v_pk_add_f32 v[58:59], v[58:59], v[28:29]
    v_exp_f32 v44, v44
    v_bfe_u32 v6, v1, 2, 2
    v_exp_f32 v45, v45
    v_pk_add_f32 v[60:61], v[60:61], v[36:37]
    v_exp_f32 v130, v130
    v_bfe_u32 v3, v1, 2, 3
    v_exp_f32 v131, v131
    v_pk_add_f32 v[62:63], v[62:63], v[44:45]
    v_exp_f32 v134, v134
    s_lshl_b32 s64, s64, 1
    v_exp_f32 v135, v135
    v_pk_add_f32 v[48:49], v[48:49], v[130:131]
    v_exp_f32 v138, v138
    v_add_f32 v48, v48, v49
    v_exp_f32 v139, v139
    v_pk_add_f32 v[50:51], v[50:51], v[134:135]
    v_exp_f32 v142, v142
    v_add_f32 v50, v50, v51
    v_exp_f32 v143, v143
    v_pk_add_f32 v[52:53], v[52:53], v[138:139]
    v_exp_f32 v22, v22
    v_add_f32 v52, v52, v53
    v_exp_f32 v23, v23
    v_pk_add_f32 v[54:55], v[54:55], v[142:143]
    v_exp_f32 v30, v30
    v_add_f32 v54, v54, v55
    v_exp_f32 v31, v31
    v_pk_add_f32 v[56:57], v[56:57], v[22:23]
    v_exp_f32 v38, v38
    v_add_f32 v56, v56, v57
    v_exp_f32 v39, v39
    v_pk_add_f32 v[58:59], v[58:59], v[30:31]
    v_exp_f32 v46, v46
    v_add_f32 v58, v58, v59
    v_exp_f32 v47, v47
    v_pk_add_f32 v[60:61], v[60:61], v[38:39]
    v_permlane16_swap_b32 v48, v50
    v_add_f32 v60, v60, v61
    v_permlane16_swap_b32 v52, v54
    v_pk_add_f32 v[62:63], v[62:63], v[46:47]
    v_permlane16_swap_b32 v56, v58
    v_add_f32 v62, v62, v63
    v_lshl_add_u32 v5, v6, 8, v5
    v_and_b32 v6, 3, v1
    v_permlane16_swap_b32 v60, v62
    v_xor_b32 v7, s64, v3
    v_add_f32 v48, v48, v50
    v_add_f32 v52, v52, v54
    s_add_u32 s64, s84, 1
    v_add_f32 v56, v56, v58
    v_permlane32_swap_b32 v48, v52
    v_add_f32 v60, v60, v62
    v_lshl_add_u32 v5, v6, 3, v5
    s_and_b32 s64, s64, 3
    v_permlane32_swap_b32 v56, v60
    v_add_u32 v5, 65536, v5
    v_and_b32 v8, 6, v1
    s_lshl_b32 s64, s64, 1
    v_add_f32 v48, v48, v52
    v_lshl_add_u32 v240, v7, 5, v5
    v_rcp_f32 v48, v48
    v_lshlrev_b32 v8, 1, v8
    v_bfe_u32 v9, v1, 3, 1
    v_xor_b32 v7, s64, v3
    v_add_f32 v56, v56, v60
    s_add_u32 s64, s84, 2
    v_rcp_f32 v56, v56
    v_lshl_or_b32 v8, v9, 1, v8
    v_and_b32 v9, 1, v1
    s_and_b32 s64, s64, 3
    v_or_b32 v8, v8, v9
    s_lshl_b32 s64, s64, 1
    v_lshrrev_b32 v9, 4, v1
    v_mov_b32 v52, v48
    v_lshl_add_u32 v242, v7, 5, v5
    v_mov_b32 v60, v56
    v_permlane32_swap_b32 v48, v52
    v_xor_b32 v7, s64, v3
    v_permlane32_swap_b32 v56, v60
    v_xor_b32 v8, v8, v9
    s_add_u32 s64, s84, 3
    v_and_b32 v9, 15, v1
    s_and_b32 s64, s64, 3
    v_lshlrev_b32 v9, 7, v9
    v_mov_b32 v50, v48
    s_lshl_b32 s64, s64, 1
    v_add_u32 v9, s60, v9
    v_permlane16_swap_b32 v48, v50
    v_xor_b32 v10, 0, v8
    v_mov_b32 v58, v56
    v_lshl_add_u32 v244, v7, 5, v5
    v_mov_b32 v54, v52
    v_permlane16_swap_b32 v56, v58
    v_xor_b32 v7, s64, v3
    v_permlane16_swap_b32 v52, v54
    v_lshl_add_u32 v248, v10, 3, v9
    s_lshl_b32 s64, s20, 11
    v_xor_b32 v10, 4, v8
    v_mov_b32 v49, v48
    v_mov_b32 v62, v60
    s_add_u32 s64, s64, 131072
    v_lshl_add_u32 v249, v10, 3, v9
    v_permlane16_swap_b32 v60, v62
    v_xor_b32 v10, 8, v8
    v_mov_b32 v57, v56
    v_mov_b32 v51, v50
    v_pk_mul_f32 v[112:113], v[112:113], v[48:49]
    v_pk_mul_f32 v[114:115], v[114:115], v[48:49]
    v_add_u32 v3, s64, v2
    v_mov_b32 v53, v52
    v_pk_mul_f32 v[128:129], v[128:129], v[48:49]
    v_pk_mul_f32 v[130:131], v[130:131], v[48:49]
    s_lshr_b32 s64, s20, 2
    v_lshl_add_u32 v250, v10, 3, v9
    v_mov_b32 v55, v54
    v_pk_mul_f32 v[16:17], v[16:17], v[56:57]
    v_pk_mul_f32 v[18:19], v[18:19], v[56:57]
    v_xor_b32 v10, 12, v8
    v_mov_b32 v59, v58
    v_pk_mul_f32 v[20:21], v[20:21], v[56:57]
    v_pk_mul_f32 v[22:23], v[22:23], v[56:57]
    v_pk_mul_f32 v[116:117], v[116:117], v[50:51]
    v_pk_mul_f32 v[118:119], v[118:119], v[50:51]
    v_pk_mul_f32 v[132:133], v[132:133], v[50:51]
    v_pk_mul_f32 v[134:135], v[134:135], v[50:51]
    v_cvt_pk_bf16_f32 v48, v112, v113
    v_cvt_pk_bf16_f32 v49, v114, v115
    v_lshl_add_u32 v246, v7, 5, v5
    v_pk_mul_f32 v[120:121], v[120:121], v[52:53]
    v_pk_mul_f32 v[122:123], v[122:123], v[52:53]
    v_pk_mul_f32 v[136:137], v[136:137], v[52:53]
    v_pk_mul_f32 v[138:139], v[138:139], v[52:53]
    v_cvt_pk_bf16_f32 v50, v128, v129
    v_cvt_pk_bf16_f32 v51, v130, v131
    v_and_b32 v7, 7, v1
    s_lshl_b32 s64, s64, 10
    v_mov_b32 v61, v60
    v_pk_mul_f32 v[124:125], v[124:125], v[54:55]
    v_pk_mul_f32 v[126:127], v[126:127], v[54:55]
    v_pk_mul_f32 v[140:141], v[140:141], v[54:55]
    v_pk_mul_f32 v[142:143], v[142:143], v[54:55]
    v_cvt_pk_bf16_f32 v52, v16, v17
    v_cvt_pk_bf16_f32 v53, v18, v19
    s_bfe_u32 s65, s20, 0x10001
    v_lshl_add_u32 v251, v10, 3, v9
    v_mov_b32 v63, v62
    v_pk_mul_f32 v[24:25], v[24:25], v[58:59]
    v_pk_mul_f32 v[26:27], v[26:27], v[58:59]
    v_cvt_pk_bf16_f32 v54, v20, v21
    v_cvt_pk_bf16_f32 v55, v22, v23
    ds_write_b64 v248, v[48:49] offset:0
    s_cmp_eq_u32 s20, 1
    s_cbranch_scc0 L_np
    buffer_load_dword v254, v252, s[44:47], 0 offen sc1
L_np:
    v_pk_mul_f32 v[28:29], v[28:29], v[58:59]
    v_pk_mul_f32 v[30:31], v[30:31], v[58:59]
    v_cvt_pk_bf16_f32 v56, v116, v117
    v_cvt_pk_bf16_f32 v57, v118, v119
    ds_write_b64 v249, v[50:51] offset:0
    v_lshlrev_b32 v7, 8, v7
    v_pk_mul_f32 v[32:33], v[32:33], v[60:61]
    v_pk_mul_f32 v[34:35], v[34:35], v[60:61]
    v_pk_mul_f32 v[36:37], v[36:37], v[60:61]
    v_pk_mul_f32 v[38:39], v[38:39], v[60:61]
    v_cvt_pk_bf16_f32 v58, v132, v133
    v_cvt_pk_bf16_f32 v59, v134, v135
    ds_write_b64 v250, v[52:53] offset:0
    s_lshl_b32 s65, s65, 3
    v_pk_mul_f32 v[40:41], v[40:41], v[62:63]
    v_pk_mul_f32 v[42:43], v[42:43], v[62:63]
    v_pk_mul_f32 v[44:45], v[44:45], v[62:63]
    v_pk_mul_f32 v[46:47], v[46:47], v[62:63]
    v_cvt_pk_bf16_f32 v60, v24, v25
    v_cvt_pk_bf16_f32 v61, v26, v27
    ds_write_b64 v251, v[54:55] offset:0
    v_cvt_pk_bf16_f32 v62, v28, v29
    v_cvt_pk_bf16_f32 v63, v30, v31
    ds_write_b64 v248, v[56:57] offset:2048
    v_lshl_add_u32 v7, v4, 4, v7
    v_cvt_pk_bf16_f32 v64, v120, v121
    v_cvt_pk_bf16_f32 v65, v122, v123
    ds_write_b64 v249, v[58:59] offset:2048
    v_lshrrev_b32 v4, 2, v1
    s_add_u32 s64, s64, s65
    v_cvt_pk_bf16_f32 v66, v136, v137
    v_cvt_pk_bf16_f32 v67, v138, v139
    ds_write_b64 v250, v[60:61] offset:2048
    v_cvt_pk_bf16_f32 v68, v32, v33
    v_cvt_pk_bf16_f32 v69, v34, v35
    ds_write_b64 v251, v[62:63] offset:2048
    v_cvt_pk_bf16_f32 v70, v36, v37
    v_cvt_pk_bf16_f32 v71, v38, v39
    ds_write_b64 v248, v[64:65] offset:4096
    v_lshlrev_b32 v4, 6, v4
    s_add_u32 s64, s64, 49152
    v_cvt_pk_bf16_f32 v72, v124, v125
    v_cvt_pk_bf16_f32 v73, v126, v127
    ds_write_b64 v249, v[66:67] offset:4096
    s_and_b32 s65, s20, 1
    v_cvt_pk_bf16_f32 v74, v140, v141
    v_cvt_pk_bf16_f32 v75, v142, v143
    ds_write_b64 v250, v[68:69] offset:4096
    v_cvt_pk_bf16_f32 v76, v40, v41
    v_cvt_pk_bf16_f32 v77, v42, v43
    ds_write_b64 v251, v[70:71] offset:4096
    v_lshl_add_u32 v4, v6, 3, v4
    v_cvt_pk_bf16_f32 v78, v44, v45
    v_cvt_pk_bf16_f32 v79, v46, v47
    ds_write_b64 v248, v[72:73] offset:6144
    v_add_u32 v6, s64, v2
    s_lshl_b32 s65, s65, 11
    ds_write_b64 v249, v[74:75] offset:6144
    ds_write_b64 v250, v[76:77] offset:6144
    ds_write_b64 v251, v[78:79] offset:6144
    v_xor_b32 v241, 32, v240
    v_xor_b32 v243, 32, v242
    v_xor_b32 v245, 32, v244
    v_xor_b32 v247, 32, v246
    v_and_b32 v15, 0xf0, v2
    v_add_u32 v4, 147456, v4
    v_add_u32 v5, s65, v6
    s_waitcnt vmcnt(0) lgkmcnt(0)
    s_cmp_eq_u32 s20, 1
    s_cbranch_scc0 L_p2_ok
    s_mov_b32 s69, 0x40000
L_p2:
    v_cmp_gt_u32 vcc, 2, v254
    s_cbranch_vccz L_p2_go
    s_sub_u32 s69, s69, 1
    s_cbranch_scc1 L_p2_go
    buffer_load_dword v254, v252, s[44:47], 0 offen sc1
    s_waitcnt vmcnt(0)
    s_branch L_p2
L_p2_go:
    s_cmp_lg_u32 s83, 0
    s_cbranch_scc1 L_p2_ok
    buffer_inv sc1
    s_waitcnt vmcnt(0)
L_p2_ok:
    s_barrier
    s_add_u32 s63, s89, 0
    buffer_load_dwordx4 v[176:179], v2, s[44:47], s63 offen sc1
    buffer_load_dwordx4 v[180:183], v2, s[44:47], s63 offen offset:1024 sc1
    s_add_u32 s63, s89, 8192
    buffer_load_dwordx4 v[184:187], v2, s[44:47], s63 offen sc1
    buffer_load_dwordx4 v[188:191], v2, s[44:47], s63 offen offset:1024 sc1
    s_branch L_phase2
L_half1:
    s_add_u32 m0, s56, 0
    s_add_u32 s60, s55, 0
    buffer_load_dwordx4 v10, s[28:31], s60 offen lds
    s_add_u32 m0, s56, 1024
    s_add_u32 s60, s55, 16384
    buffer_load_dwordx4 v10, s[28:31], s60 offen lds
    s_add_u32 m0, s56, 2048
    s_add_u32 s60, s55, 32768
    buffer_load_dwordx4 v10, s[28:31], s60 offen lds
    s_add_u32 m0, s56, 3072
    s_add_u32 s60, s55, 49152
    buffer_load_dwordx4 v10, s[28:31], s60 offen lds
    s_add_u32 m0, s56, 4096
    s_add_u32 s60, s55, 65536
    buffer_load_dwordx4 v10, s[28:31], s60 offen lds
    s_add_u32 s55, s55, 128
    s_add_u32 m0, s54, 0
    s_nop 0
    buffer_load_dwordx4 v11, s[32:35], s52 offen lds
    s_add_u32 m0, s54, 1024
    s_nop 0
    buffer_load_dwordx4 v12, s[36:39], s52 offen lds
    s_add_u32 s52, s52, s53
    s_load_dwordx4 s[8:11], s[0:1], 16
    s_load_dwordx4 s[72:75], s[0:1], 56
    s_load_dwordx2 s[80:81], s[0:1], 72
    s_load_dwordx4 s[16:19], s[0:1], 80
    v_lshrrev_b32 v14, 4, v1
    v_bfe_u32 v15, v1, 2, 2
    v_and_b32 v16, 3, v1
    v_lshrrev_b32 v17, 1, v14
    v_and_b32 v18, 1, v14
    v_lshlrev_b32 v19, 4, v17
    v_lshl_add_u32 v19, v18, 2, v19
    v_add_u32 v19, v19, v15
    v_mul_u32_u24 v20, 224, v19
    v_lshl_add_u32 v20, v16, 3, v20
    v_add_u32 v4, 65536, v20
    v_add_u32 v5, 106496, v20
    v_and_b32 v19, 15, v1
    v_and_b32 v20, 6, v1
    v_xor_b32 v20, v20, v14
    v_lshlrev_b32 v20, 4, v20
    v_lshl_add_u32 v20, v19, 7, v20
    s_lshl_b32 s61, s22, 13
    v_add_u32 v2, s61, v20
    v_xor_b32 v3, 64, v2
    s_add_u32 m0, s54, 20480
    s_nop 0
    buffer_load_dwordx4 v11, s[32:35], s52 offen lds
    s_add_u32 m0, s54, 21504
    s_nop 0
    buffer_load_dwordx4 v12, s[36:39], s52 offen lds
    s_add_u32 s52, s52, s53
    v_mov_b32 v240, -1
    v_mov_b32 v241, -1
    v_mov_b32 v242, -1
    v_mov_b32 v243, -1
    v_lshlrev_b32 v15, 4, v1
    v_and_b32 v244, 0x30, v1
    v_lshlrev_b32 v245, 2, v0
    s_lshl_b32 s25, s23, 3
    s_add_u32 s25, s25, s85
    s_lshl_b32 s25, s25, 2
    s_add_u32 s25, s25, s84
    s_mul_i32 s25, s25, 49152
    s_lshl_b32 s61, s20, 11
    s_add_u32 s25, s25, s61
    s_add_u32 s25, s25, 23068672
    s_lshl_b32 s95, s23, 3
    s_add_u32 s95, s95, s85
    s_lshl_b32 s95, s95, 3
    s_add_u32 s95, s95, s20
    s_lshl_b32 s95, s95, 2
    s_add_u32 s95, s95, s84
    s_lshl_b32 s95, s95, 6
    s_add_u32 s95, s95, 19136512
    s_lshl_b32 s98, s24, 3
    s_add_u32 s98, s98, s23
    s_lshl_b32 s99, s98, 13
    s_lshl_b32 s100, s22, 11
    s_add_u32 s99, s99, s100
    s_add_u32 s99, s99, 20971520
    s_lshl_b32 s100, s98, 8
    s_lshl_b32 s101, s22, 6
    s_add_u32 s100, s100, s101
    s_add_u32 s100, s100, 18874368
    s_getreg_b32 s82, hwreg(HW_REG_XCC_ID, 0, 4)
    s_and_b32 s82, s82, 7
    s_add_u32 s82, s82, 1
    v_and_b32 v16, 31, v1
    v_lshl_add_u32 v16, v16, 3, s23
    v_and_b32 v17, 7, v1
    s_lshl_b32 s61, s24, 3
    v_add_u32 v17, s61, v17
    v_cmp_gt_u32 vcc, 32, v1
    s_nop 1
    v_cndmask_b32 v248, v17, v16, vcc
    v_mov_b32 v249, 0
    s_lshl_b32 s3, s23, 5
    s_add_u32 s3, s3, s24
    s_lshl_b32 s3, s3, 7
    s_add_u32 s3, s3, 19005440
    s_cmp_eq_u32 s20, 0
    s_cselect_b32 s60, 64, 224
    s_cselect_b32 s61, 64, 32
    s_mul_i32 s60, s60, s2
    s_lshl_b32 s62, s20, 5
    s_max_u32 s62, s62, 32
    s_add_u32 s60, s60, s62
    s_sub_u32 s60, s60, 32
    v_add_u32 v14, s60, v1
    v_lshlrev_b32 v14, 7, v14
    v_cmp_gt_u32 vcc, s61, v1
    s_nop 1
    v_cndmask_b32 v14, -1, v14, vcc
    s_waitcnt lgkmcnt(0)
    s_mov_b64 s[4:5], s[16:17]
    s_mov_b32 s6, 256
    s_mov_b32 s7, 0x20000
    s_mov_b64 s[44:45], s[18:19]
    s_mov_b32 s46, 0x10000000
    s_mov_b32 s47, 0x20000
    s_lshl_b32 s60, s24, 11
    s_add_u32 s48, s8, s60
    s_addc_u32 s49, s9, 0
    s_mov_b32 s50, 2048
    s_mov_b32 s51, 0x20000
    s_cmp_eq_u32 s20, 0
    s_cselect_b64 s[76:77], s[10:11], s[72:73]
    s_mov_b32 s78, 7340032
    s_cselect_b32 s78, 2097152, s78
    s_mov_b32 s79, 0x20000
    s_lshl_b32 s60, s22, 13
    s_mul_i32 s86, s84, 1835008
    s_add_u32 s86, s86, s60
    s_mul_i32 s87, s21, 229376
    s_add_u32 s87, s87, s86
    s_add_u32 s87, s87, 196608
    s_lshl_b32 s88, s84, 19
    s_add_u32 s88, s88, s60
    s_lshl_b32 s60, s21, 15
    s_add_u32 s86, s86, s60
    s_add_u32 s88, s88, s60
    s_lshl_b32 s91, s20, 10
    s_add_u32 s91, s91, 65536
    s_lshl_b32 s60, s23, 1
    s_add_u32 s60, s60, s21
    s_mul_i32 s60, s60, 1179648
    s_lshl_b32 s61, s22, 11
    s_add_u32 s60, s60, s61
    s_mul_i32 s89, s84, 196608
    s_add_u32 s89, s89, 262144
    s_add_u32 s89, s89, s60
    s_lshl_b32 s90, s84, 15
    s_add_u32 s90, s90, 1048576
    s_add_u32 s90, s90, s60
    s_lshl_b32 s92, s84, 16
    s_add_u32 s92, s92, s60
    s_lshl_b32 s93, s24, 13
    s_add_u32 s93, s93, s60
    s_lshl_b32 s13, s23, 12
    s_lshl_b32 s60, s20, 9
    s_add_u32 s13, s13, s60
    s_add_u32 s13, s13, 18939904
    s_lshl_b32 s94, s24, 16
    s_lshl_b32 s60, s20, 10
    s_add_u32 s94, s94, s60
    s_add_u32 s94, s94, 20971520
    s_lshl_b32 s12, s24, 11
    s_lshr_b32 s60, s20, 1
    s_lshl_b32 s61, s60, 6
    s_add_u32 s12, s12, s61
    s_add_u32 s12, s12, 18874368
    s_lshr_b32 s60, s22, 1
    s_lshl_b32 s61, s23, 1
    s_add_u32 s60, s60, s61
    s_mul_i32 s26, s60, 1179648
    s_and_b32 s60, s22, 1
    s_lshl_b32 s60, s60, 12
    s_add_u32 s26, s26, s60
    s_mov_b32 s58, 1069066811
    s_mov_b32 s59, 1069066811
    s_waitcnt vmcnt(2)
    s_barrier
    ds_read_b64_tr_b16 v[48:49], v4 offset:6208
    ds_read_b64_tr_b16 v[50:51], v4 offset:8000
    ds_read_b128 v[16:19], v2 offset:0
    ds_read_b128 v[20:23], v2 offset:2048
    ds_read_b128 v[24:27], v2 offset:4096
    ds_read_b128 v[28:31], v2 offset:6144
    ds_read_b64_tr_b16 v[52:53], v4 offset:6240
    ds_read_b64_tr_b16 v[54:55], v4 offset:8032
    ds_read_b64_tr_b16 v[56:57], v4 offset:6272
    ds_read_b64_tr_b16 v[58:59], v4 offset:8064
    ds_read_b64_tr_b16 v[60:61], v4 offset:6304
    ds_read_b64_tr_b16 v[62:63], v4 offset:8096
    ds_read_b64_tr_b16 v[64:65], v4 offset:6336
    ds_read_b64_tr_b16 v[66:67], v4 offset:8128
    s_mov_b32 s57, 8
    s_waitcnt lgkmcnt(11)
    v_mfma_f32_16x16x32_bf16 v[80:83], v[48:51], v[16:19], 0
    ds_read_b64_tr_b16 v[68:69], v4 offset:13376
    ds_read_b64_tr_b16 v[70:71], v4 offset:15168
    s_waitcnt lgkmcnt(12)
    v_mfma_f32_16x16x32_bf16 v[84:87], v[48:51], v[20:23], 0
    ds_read_b128 v[32:35], v3 offset:0
    s_waitcnt lgkmcnt(12)
    v_mfma_f32_16x16x32_bf16 v[88:91], v[48:51], v[24:27], 0
    s_add_u32 m0, s56, 32768
    s_add_u32 s60, s55, 0
    buffer_load_dwordx4 v10, s[28:31], s60 offen lds
    s_waitcnt lgkmcnt(11)
    v_mfma_f32_16x16x32_bf16 v[92:95], v[48:51], v[28:31], 0
    s_add_u32 m0, s56, 33792
    s_add_u32 s60, s55, 16384
    buffer_load_dwordx4 v10, s[28:31], s60 offen lds
    s_waitcnt lgkmcnt(9)
    v_mfma_f32_16x16x32_bf16 v[108:111], v[52:55], v[28:31], 0
    ds_read_b64_tr_b16 v[72:73], v4 offset:13408
    v_mfma_f32_16x16x32_bf16 v[104:107], v[52:55], v[24:27], 0
    ds_read_b64_tr_b16 v[74:75], v4 offset:15200
    v_mfma_f32_16x16x32_bf16 v[100:103], v[52:55], v[20:23], 0
    ds_read_b128 v[36:39], v3 offset:2048
    v_mfma_f32_16x16x32_bf16 v[96:99], v[52:55], v[16:19], 0
    s_add_u32 m0, s56, 34816
    s_add_u32 s60, s55, 32768
    buffer_load_dwordx4 v10, s[28:31], s60 offen lds
    s_waitcnt lgkmcnt(10)
    v_mfma_f32_16x16x32_bf16 v[112:115], v[56:59], v[16:19], 0
    ds_read_b64_tr_b16 v[76:77], v4 offset:13440
    ds_read_b64_tr_b16 v[78:79], v4 offset:15232
    v_mfma_f32_16x16x32_bf16 v[116:119], v[56:59], v[20:23], 0
    ds_read_b128 v[40:43], v3 offset:4096
    v_mfma_f32_16x16x32_bf16 v[120:123], v[56:59], v[24:27], 0
    s_add_u32 m0, s56, 35840
    s_add_u32 s60, s55, 49152
    buffer_load_dwordx4 v10, s[28:31], s60 offen lds
    v_mfma_f32_16x16x32_bf16 v[124:127], v[56:59], v[28:31], 0
    s_add_u32 m0, s56, 36864
    s_add_u32 s60, s55, 65536
    buffer_load_dwordx4 v10, s[28:31], s60 offen lds
    s_add_u32 s55, s55, 128
    s_waitcnt lgkmcnt(11)
    v_mfma_f32_16x16x32_bf16 v[140:143], v[60:63], v[28:31], 0
    ds_read_b64_tr_b16 v[48:49], v4 offset:13472
    v_mfma_f32_16x16x32_bf16 v[136:139], v[60:63], v[24:27], 0
    ds_read_b64_tr_b16 v[50:51], v4 offset:15264
    v_mfma_f32_16x16x32_bf16 v[132:135], v[60:63], v[20:23], 0
    ds_read_b128 v[44:47], v3 offset:6144
    v_mfma_f32_16x16x32_bf16 v[128:131], v[60:63], v[16:19], 0
    s_add_u32 m0, s54, 40960
    s_nop 0
    buffer_load_dwordx4 v11, s[32:35], s52 offen lds
    s_waitcnt lgkmcnt(12)
    v_mfma_f32_16x16x32_bf16 v[144:147], v[64:67], v[16:19], 0
    ds_read_b64_tr_b16 v[52:53], v4 offset:13504
    v_mfma_f32_16x16x32_bf16 v[148:151], v[64:67], v[20:23], 0
    ds_read_b64_tr_b16 v[54:55], v4 offset:15296
    v_mfma_f32_16x16x32_bf16 v[152:155], v[64:67], v[24:27], 0
    s_add_u32 m0, s54, 41984
    s_nop 0
    buffer_load_dwordx4 v12, s[36:39], s52 offen lds
    s_add_u32 s52, s52, s53
    v_mfma_f32_16x16x32_bf16 v[156:159], v[64:67], v[28:31], 0
    s_add_u32 m0, s54, 61440
    s_nop 0
    buffer_load_dwordx4 v11, s[32:35], s52 offen lds
    s_waitcnt lgkmcnt(12)
    v_mfma_f32_16x16x32_bf16 v[172:175], v[68:71], v[28:31], 0
    s_add_u32 m0, s54, 62464
    s_nop 0
    buffer_load_dwordx4 v12, s[36:39], s52 offen lds
    s_add_u32 s52, s52, s53
    v_mfma_f32_16x16x32_bf16 v[168:171], v[68:71], v[24:27], 0
    v_mfma_f32_16x16x32_bf16 v[164:167], v[68:71], v[20:23], 0
    v_mfma_f32_16x16x32_bf16 v[160:163], v[68:71], v[16:19], 0
    s_waitcnt lgkmcnt(9)
    v_mfma_f32_16x16x32_bf16 v[176:179], v[72:75], v[16:19], 0
    s_lshl_b32 s60, s20, 8
    s_add_u32 m0, s60, 147456
    s_nop 0
    buffer_load_dword v245, s[48:51], 0 offen lds
    v_mfma_f32_16x16x32_bf16 v[180:183], v[72:75], v[20:23], 0
    v_mfma_f32_16x16x32_bf16 v[184:187], v[72:75], v[24:27], 0
    v_mfma_f32_16x16x32_bf16 v[188:191], v[72:75], v[28:31], 0
    s_waitcnt vmcnt(10) lgkmcnt(0)
    s_barrier
    v_mfma_f32_16x16x32_bf16 v[204:207], v[76:79], v[28:31], 0
    ds_read_b64_tr_b16 v[56:57], v4 offset:26688
    v_mfma_f32_16x16x32_bf16 v[200:203], v[76:79], v[24:27], 0
    ds_read_b64_tr_b16 v[58:59], v4 offset:28480
    v_mfma_f32_16x16x32_bf16 v[196:199], v[76:79], v[20:23], 0
    ds_read_b64_tr_b16 v[60:61], v4 offset:26720
    v_mfma_f32_16x16x32_bf16 v[192:195], v[76:79], v[16:19], 0
    ds_read_b64_tr_b16 v[62:63], v4 offset:28512
    v_mfma_f32_16x16x32_bf16 v[208:211], v[48:51], v[16:19], 0
    ds_read_b64_tr_b16 v[64:65], v4 offset:26752
    v_mfma_f32_16x16x32_bf16 v[212:215], v[48:51], v[20:23], 0
    ds_read_b64_tr_b16 v[66:67], v4 offset:28544
    v_mfma_f32_16x16x32_bf16 v[216:219], v[48:51], v[24:27], 0
    ds_read_b64_tr_b16 v[68:69], v4 offset:26784
    v_mfma_f32_16x16x32_bf16 v[220:223], v[48:51], v[28:31], 0
    ds_read_b64_tr_b16 v[70:71], v4 offset:28576
    v_mfma_f32_16x16x32_bf16 v[236:239], v[52:55], v[28:31], 0
    ds_read_b64_tr_b16 v[72:73], v4 offset:26816
    v_mfma_f32_16x16x32_bf16 v[232:235], v[52:55], v[24:27], 0
    ds_read_b64_tr_b16 v[74:75], v4 offset:28608
    v_mfma_f32_16x16x32_bf16 v[228:231], v[52:55], v[20:23], 0
    v_mfma_f32_16x16x32_bf16 v[224:227], v[52:55], v[16:19], 0
    s_branch L_loop1_u1
    .p2align 6
L_loop1:
    s_waitcnt lgkmcnt(11)
    v_mfma_f32_16x16x32_bf16 v[80:83], v[48:51], v[16:19], v[80:83]
    ds_read_b64_tr_b16 v[68:69], v4 offset:13376
    s_waitcnt lgkmcnt(11)
    v_mfma_f32_16x16x32_bf16 v[84:87], v[48:51], v[20:23], v[84:87]
    ds_read_b64_tr_b16 v[70:71], v4 offset:15168
    s_waitcnt lgkmcnt(11)
    v_mfma_f32_16x16x32_bf16 v[88:91], v[48:51], v[24:27], v[88:91]
    ds_read_b128 v[32:35], v3 offset:0
    s_waitcnt lgkmcnt(11)
    v_mfma_f32_16x16x32_bf16 v[92:95], v[48:51], v[28:31], v[92:95]
    s_waitcnt lgkmcnt(9)
    v_mfma_f32_16x16x32_bf16 v[108:111], v[52:55], v[28:31], v[108:111]
    ds_read_b64_tr_b16 v[72:73], v4 offset:13408
    v_mfma_f32_16x16x32_bf16 v[104:107], v[52:55], v[24:27], v[104:107]
    ds_read_b64_tr_b16 v[74:75], v4 offset:15200
    v_mfma_f32_16x16x32_bf16 v[100:103], v[52:55], v[20:23], v[100:103]
    ds_read_b128 v[36:39], v3 offset:2048
    v_mfma_f32_16x16x32_bf16 v[96:99], v[52:55], v[16:19], v[96:99]
    s_add_u32 m0, s54, 61440
    s_nop 0
    buffer_load_dwordx4 v11, s[32:35], s52 offen lds
    s_waitcnt lgkmcnt(10)
    v_mfma_f32_16x16x32_bf16 v[112:115], v[56:59], v[16:19], v[112:115]
    ds_read_b64_tr_b16 v[76:77], v4 offset:13440
    v_mfma_f32_16x16x32_bf16 v[116:119], v[56:59], v[20:23], v[116:119]
    ds_read_b64_tr_b16 v[78:79], v4 offset:15232
    v_mfma_f32_16x16x32_bf16 v[120:123], v[56:59], v[24:27], v[120:123]
    ds_read_b128 v[40:43], v3 offset:4096
    v_mfma_f32_16x16x32_bf16 v[124:127], v[56:59], v[28:31], v[124:127]
    s_waitcnt lgkmcnt(11)
    v_mfma_f32_16x16x32_bf16 v[140:143], v[60:63], v[28:31], v[140:143]
    ds_read_b64_tr_b16 v[48:49], v4 offset:13472
    v_mfma_f32_16x16x32_bf16 v[136:139], v[60:63], v[24:27], v[136:139]
    ds_read_b64_tr_b16 v[50:51], v4 offset:15264
    v_mfma_f32_16x16x32_bf16 v[132:135], v[60:63], v[20:23], v[132:135]
    ds_read_b128 v[44:47], v3 offset:6144
    v_mfma_f32_16x16x32_bf16 v[128:131], v[60:63], v[16:19], v[128:131]
    s_add_u32 m0, s54, 62464
    s_nop 0
    buffer_load_dwordx4 v12, s[36:39], s52 offen lds
    s_add_u32 s52, s52, s53
    s_waitcnt lgkmcnt(12)
    v_mfma_f32_16x16x32_bf16 v[144:147], v[64:67], v[16:19], v[144:147]
    ds_read_b64_tr_b16 v[52:53], v4 offset:13504
    v_mfma_f32_16x16x32_bf16 v[148:151], v[64:67], v[20:23], v[148:151]
    ds_read_b64_tr_b16 v[54:55], v4 offset:15296
    v_mfma_f32_16x16x32_bf16 v[152:155], v[64:67], v[24:27], v[152:155]
    v_mfma_f32_16x16x32_bf16 v[156:159], v[64:67], v[28:31], v[156:159]
    s_waitcnt lgkmcnt(12)
    v_mfma_f32_16x16x32_bf16 v[172:175], v[68:71], v[28:31], v[172:175]
    v_mfma_f32_16x16x32_bf16 v[168:171], v[68:71], v[24:27], v[168:171]
    v_mfma_f32_16x16x32_bf16 v[164:167], v[68:71], v[20:23], v[164:167]
    v_mfma_f32_16x16x32_bf16 v[160:163], v[68:71], v[16:19], v[160:163]
    s_waitcnt lgkmcnt(9)
    v_mfma_f32_16x16x32_bf16 v[176:179], v[72:75], v[16:19], v[176:179]
    v_mfma_f32_16x16x32_bf16 v[180:183], v[72:75], v[20:23], v[180:183]
    v_mfma_f32_16x16x32_bf16 v[184:187], v[72:75], v[24:27], v[184:187]
    v_mfma_f32_16x16x32_bf16 v[188:191], v[72:75], v[28:31], v[188:191]
    s_waitcnt vmcnt(9) lgkmcnt(0)
    s_barrier
    v_mfma_f32_16x16x32_bf16 v[204:207], v[76:79], v[28:31], v[204:207]
    ds_read_b64_tr_b16 v[56:57], v4 offset:26688
    v_mfma_f32_16x16x32_bf16 v[200:203], v[76:79], v[24:27], v[200:203]
    ds_read_b64_tr_b16 v[58:59], v4 offset:28480
    v_mfma_f32_16x16x32_bf16 v[196:199], v[76:79], v[20:23], v[196:199]
    ds_read_b64_tr_b16 v[60:61], v4 offset:26720
    v_mfma_f32_16x16x32_bf16 v[192:195], v[76:79], v[16:19], v[192:195]
    ds_read_b64_tr_b16 v[62:63], v4 offset:28512
    v_mfma_f32_16x16x32_bf16 v[208:211], v[48:51], v[16:19], v[208:211]
    ds_read_b64_tr_b16 v[64:65], v4 offset:26752
    v_mfma_f32_16x16x32_bf16 v[212:215], v[48:51], v[20:23], v[212:215]
    ds_read_b64_tr_b16 v[66:67], v4 offset:28544
    v_mfma_f32_16x16x32_bf16 v[216:219], v[48:51], v[24:27], v[216:219]
    ds_read_b64_tr_b16 v[68:69], v4 offset:26784
    v_mfma_f32_16x16x32_bf16 v[220:223], v[48:51], v[28:31], v[220:223]
    ds_read_b64_tr_b16 v[70:71], v4 offset:28576
    v_mfma_f32_16x16x32_bf16 v[236:239], v[52:55], v[28:31], v[236:239]
    ds_read_b64_tr_b16 v[72:73], v4 offset:26816
    v_mfma_f32_16x16x32_bf16 v[232:235], v[52:55], v[24:27], v[232:235]
    ds_read_b64_tr_b16 v[74:75], v4 offset:28608
    v_mfma_f32_16x16x32_bf16 v[228:231], v[52:55], v[20:23], v[228:231]
    v_mfma_f32_16x16x32_bf16 v[224:227], v[52:55], v[16:19], v[224:227]
L_loop1_u1:
    s_cmp_eq_u32 s57, 7
    s_cbranch_scc0 L_loop1_j7
    s_mov_b64 exec, 1
    buffer_store_dword v249, off, s[44:47], s95 sc1
    s_cmp_eq_u32 s20, 4
    s_cbranch_scc0 L_loop1_j7b
    buffer_store_dword v249, off, s[44:47], s3 sc1
    s_add_u32 s60, s3, 0x8000
    buffer_store_dword v249, off, s[44:47], s60 sc1
L_loop1_j7b:
    s_mov_b64 exec, -1
L_loop1_j7:
    s_cmp_eq_u32 s57, 4
    s_cbranch_scc0 L_loop1_j4
    s_cmp_eq_u32 s20, 4
    s_cbranch_scc0 L_loop1_j4
    v_mov_b32 v254, s82
    s_mov_b64 exec, 1
    buffer_store_byte v254, off, s[4:7], s98 sc1
    s_mov_b64 exec, -1
L_loop1_j4:
    s_cmp_eq_u32 s57, 1
    s_cbranch_scc0 L_loop1_j1
    s_mov_b32 s54, 163840
    s_mov_b32 s56, 163840
    s_mov_b32 s55, 0x40000000
    buffer_load_ubyte v247, v248, s[4:7], 0 offen sc1
    buffer_load_dword v246, v14, s[76:79], 0 offen
L_loop1_j1:
    s_waitcnt lgkmcnt(8)
    v_mfma_f32_16x16x32_bf16 v[80:83], v[56:59], v[32:35], v[80:83]
    ds_read_b64_tr_b16 v[76:77], v4 offset:33856
    v_mfma_f32_16x16x32_bf16 v[84:87], v[56:59], v[36:39], v[84:87]
    ds_read_b64_tr_b16 v[78:79], v4 offset:35648
    v_mfma_f32_16x16x32_bf16 v[88:91], v[56:59], v[40:43], v[88:91]
    s_add_u32 m0, s56, 0
    s_add_u32 s60, s55, 0
    buffer_load_dwordx4 v10, s[28:31], s60 offen lds
    v_mfma_f32_16x16x32_bf16 v[92:95], v[56:59], v[44:47], v[92:95]
    s_waitcnt lgkmcnt(8)
    v_mfma_f32_16x16x32_bf16 v[108:111], v[60:63], v[44:47], v[108:111]
    ds_read_b64_tr_b16 v[48:49], v4 offset:33888
    v_mfma_f32_16x16x32_bf16 v[104:107], v[60:63], v[40:43], v[104:107]
    ds_read_b64_tr_b16 v[50:51], v4 offset:35680
    v_mfma_f32_16x16x32_bf16 v[100:103], v[60:63], v[36:39], v[100:103]
    s_add_u32 m0, s56, 1024
    s_add_u32 s60, s55, 16384
    buffer_load_dwordx4 v10, s[28:31], s60 offen lds
    v_mfma_f32_16x16x32_bf16 v[96:99], v[60:63], v[32:35], v[96:99]
    s_waitcnt lgkmcnt(8)
    v_mfma_f32_16x16x32_bf16 v[112:115], v[64:67], v[32:35], v[112:115]
    ds_read_b64_tr_b16 v[52:53], v4 offset:33920
    v_mfma_f32_16x16x32_bf16 v[116:119], v[64:67], v[36:39], v[116:119]
    ds_read_b64_tr_b16 v[54:55], v4 offset:35712
    v_mfma_f32_16x16x32_bf16 v[120:123], v[64:67], v[40:43], v[120:123]
    s_add_u32 m0, s56, 2048
    s_add_u32 s60, s55, 32768
    buffer_load_dwordx4 v10, s[28:31], s60 offen lds
    v_mfma_f32_16x16x32_bf16 v[124:127], v[64:67], v[44:47], v[124:127]
    s_waitcnt lgkmcnt(8)
    v_mfma_f32_16x16x32_bf16 v[140:143], v[68:71], v[44:47], v[140:143]
    ds_read_b64_tr_b16 v[56:57], v4 offset:33952
    v_mfma_f32_16x16x32_bf16 v[136:139], v[68:71], v[40:43], v[136:139]
    ds_read_b64_tr_b16 v[58:59], v4 offset:35744
    v_mfma_f32_16x16x32_bf16 v[132:135], v[68:71], v[36:39], v[132:135]
    s_add_u32 m0, s56, 3072
    s_add_u32 s60, s55, 49152
    buffer_load_dwordx4 v10, s[28:31], s60 offen lds
    v_mfma_f32_16x16x32_bf16 v[128:131], v[68:71], v[32:35], v[128:131]
    s_waitcnt lgkmcnt(8)
    v_mfma_f32_16x16x32_bf16 v[144:147], v[72:75], v[32:35], v[144:147]
    ds_read_b64_tr_b16 v[60:61], v4 offset:33984
    v_mfma_f32_16x16x32_bf16 v[148:151], v[72:75], v[36:39], v[148:151]
    ds_read_b64_tr_b16 v[62:63], v4 offset:35776
    v_mfma_f32_16x16x32_bf16 v[152:155], v[72:75], v[40:43], v[152:155]
    s_add_u32 m0, s56, 4096
    s_add_u32 s60, s55, 65536
    buffer_load_dwordx4 v10, s[28:31], s60 offen lds
    s_add_u32 s55, s55, 128
    v_mfma_f32_16x16x32_bf16 v[156:159], v[72:75], v[44:47], v[156:159]
    s_waitcnt lgkmcnt(8)
    v_mfma_f32_16x16x32_bf16 v[172:175], v[76:79], v[44:47], v[172:175]
    s_add_u32 m0, s54, 0
    s_nop 0
    buffer_load_dwordx4 v11, s[32:35], s52 offen lds
    v_mfma_f32_16x16x32_bf16 v[168:171], v[76:79], v[40:43], v[168:171]
    v_mfma_f32_16x16x32_bf16 v[164:167], v[76:79], v[36:39], v[164:167]
    v_mfma_f32_16x16x32_bf16 v[160:163], v[76:79], v[32:35], v[160:163]
    s_waitcnt lgkmcnt(6)
    v_mfma_f32_16x16x32_bf16 v[176:179], v[48:51], v[32:35], v[176:179]
    s_add_u32 m0, s54, 1024
    s_nop 0
    buffer_load_dwordx4 v12, s[36:39], s52 offen lds
    s_add_u32 s52, s52, s53
    v_mfma_f32_16x16x32_bf16 v[180:183], v[48:51], v[36:39], v[180:183]
    v_mfma_f32_16x16x32_bf16 v[184:187], v[48:51], v[40:43], v[184:187]
    v_mfma_f32_16x16x32_bf16 v[188:191], v[48:51], v[44:47], v[188:191]
    s_cmp_eq_u32 s57, 1
    s_cbranch_scc1 L_loop1_r1
    s_waitcnt vmcnt(9)
L_loop1_r1:
    s_waitcnt vmcnt(9) lgkmcnt(0)
    s_barrier
    s_cbranch_scc1 L_tail1
    v_mfma_f32_16x16x32_bf16 v[204:207], v[52:55], v[44:47], v[204:207]
    ds_read_b64_tr_b16 v[64:65], v5 offset:6208
    ds_read_b64_tr_b16 v[66:67], v5 offset:8000
    v_mfma_f32_16x16x32_bf16 v[200:203], v[52:55], v[40:43], v[200:203]
    ds_read_b128 v[16:19], v2 offset:32768
    v_mfma_f32_16x16x32_bf16 v[196:199], v[52:55], v[36:39], v[196:199]
    ds_read_b128 v[20:23], v2 offset:34816
    v_mfma_f32_16x16x32_bf16 v[192:195], v[52:55], v[32:35], v[192:195]
    ds_read_b128 v[24:27], v2 offset:36864
    v_mfma_f32_16x16x32_bf16 v[208:211], v[56:59], v[32:35], v[208:211]
    ds_read_b128 v[28:31], v2 offset:38912
    ds_read_b64_tr_b16 v[68:69], v5 offset:6240
    v_mfma_f32_16x16x32_bf16 v[212:215], v[56:59], v[36:39], v[212:215]
    ds_read_b64_tr_b16 v[70:71], v5 offset:8032
    v_mfma_f32_16x16x32_bf16 v[216:219], v[56:59], v[40:43], v[216:219]
    ds_read_b64_tr_b16 v[72:73], v5 offset:6272
    v_mfma_f32_16x16x32_bf16 v[220:223], v[56:59], v[44:47], v[220:223]
    ds_read_b64_tr_b16 v[74:75], v5 offset:8064
    v_mfma_f32_16x16x32_bf16 v[236:239], v[60:63], v[44:47], v[236:239]
    ds_read_b64_tr_b16 v[76:77], v5 offset:6304
    v_mfma_f32_16x16x32_bf16 v[232:235], v[60:63], v[40:43], v[232:235]
    ds_read_b64_tr_b16 v[78:79], v5 offset:8096
    v_mfma_f32_16x16x32_bf16 v[228:231], v[60:63], v[36:39], v[228:231]
    ds_read_b64_tr_b16 v[48:49], v5 offset:6336
    v_mfma_f32_16x16x32_bf16 v[224:227], v[60:63], v[32:35], v[224:227]
    ds_read_b64_tr_b16 v[50:51], v5 offset:8128
    s_waitcnt lgkmcnt(11)
    v_mfma_f32_16x16x32_bf16 v[80:83], v[64:67], v[16:19], v[80:83]
    ds_read_b64_tr_b16 v[52:53], v5 offset:13376
    s_waitcnt lgkmcnt(11)
    v_mfma_f32_16x16x32_bf16 v[84:87], v[64:67], v[20:23], v[84:87]
    ds_read_b64_tr_b16 v[54:55], v5 offset:15168
    s_waitcnt lgkmcnt(11)
    v_mfma_f32_16x16x32_bf16 v[88:91], v[64:67], v[24:27], v[88:91]
    ds_read_b128 v[32:35], v3 offset:32768
    s_waitcnt lgkmcnt(11)
    v_mfma_f32_16x16x32_bf16 v[92:95], v[64:67], v[28:31], v[92:95]
    s_waitcnt lgkmcnt(9)
    v_mfma_f32_16x16x32_bf16 v[108:111], v[68:71], v[28:31], v[108:111]
    ds_read_b64_tr_b16 v[56:57], v5 offset:13408
    v_mfma_f32_16x16x32_bf16 v[104:107], v[68:71], v[24:27], v[104:107]
    ds_read_b64_tr_b16 v[58:59], v5 offset:15200
    v_mfma_f32_16x16x32_bf16 v[100:103], v[68:71], v[20:23], v[100:103]
    ds_read_b128 v[36:39], v3 offset:34816
    v_mfma_f32_16x16x32_bf16 v[96:99], v[68:71], v[16:19], v[96:99]
    s_add_u32 m0, s54, 20480
    s_nop 0
    buffer_load_dwordx4 v11, s[32:35], s52 offen lds
    s_waitcnt lgkmcnt(10)
    v_mfma_f32_16x16x32_bf16 v[112:115], v[72:75], v[16:19], v[112:115]
    ds_read_b64_tr_b16 v[60:61], v5 offset:13440
    v_mfma_f32_16x16x32_bf16 v[116:119], v[72:75], v[20:23], v[116:119]
    ds_read_b64_tr_b16 v[62:63], v5 offset:15232
    v_mfma_f32_16x16x32_bf16 v[120:123], v[72:75], v[24:27], v[120:123]
    ds_read_b128 v[40:43], v3 offset:36864
    v_mfma_f32_16x16x32_bf16 v[124:127], v[72:75], v[28:31], v[124:127]
    s_waitcnt lgkmcnt(11)
    v_mfma_f32_16x16x32_bf16 v[140:143], v[76:79], v[28:31], v[140:143]
    ds_read_b64_tr_b16 v[64:65], v5 offset:13472
    v_mfma_f32_16x16x32_bf16 v[136:139], v[76:79], v[24:27], v[136:139]
    ds_read_b64_tr_b16 v[66:67], v5 offset:15264
    v_mfma_f32_16x16x32_bf16 v[132:135], v[76:79], v[20:23], v[132:135]
    ds_read_b128 v[44:47], v3 offset:38912
    v_mfma_f32_16x16x32_bf16 v[128:131], v[76:79], v[16:19], v[128:131]
    s_add_u32 m0, s54, 21504
    s_nop 0
    buffer_load_dwordx4 v12, s[36:39], s52 offen lds
    s_add_u32 s52, s52, s53
    s_waitcnt lgkmcnt(12)
    v_mfma_f32_16x16x32_bf16 v[144:147], v[48:51], v[16:19], v[144:147]
    ds_read_b64_tr_b16 v[68:69], v5 offset:13504
    v_mfma_f32_16x16x32_bf16 v[148:151], v[48:51], v[20:23], v[148:151]
    ds_read_b64_tr_b16 v[70:71], v5 offset:15296
    v_mfma_f32_16x16x32_bf16 v[152:155], v[48:51], v[24:27], v[152:155]
    v_mfma_f32_16x16x32_bf16 v[156:159], v[48:51], v[28:31], v[156:159]
    s_waitcnt lgkmcnt(12)
    v_mfma_f32_16x16x32_bf16 v[172:175], v[52:55], v[28:31], v[172:175]
    v_mfma_f32_16x16x32_bf16 v[168:171], v[52:55], v[24:27], v[168:171]
    v_mfma_f32_16x16x32_bf16 v[164:167], v[52:55], v[20:23], v[164:167]
    v_mfma_f32_16x16x32_bf16 v[160:163], v[52:55], v[16:19], v[160:163]
    s_waitcnt lgkmcnt(9)
    v_mfma_f32_16x16x32_bf16 v[176:179], v[56:59], v[16:19], v[176:179]
    v_mfma_f32_16x16x32_bf16 v[180:183], v[56:59], v[20:23], v[180:183]
    v_mfma_f32_16x16x32_bf16 v[184:187], v[56:59], v[24:27], v[184:187]
    v_mfma_f32_16x16x32_bf16 v[188:191], v[56:59], v[28:31], v[188:191]
    s_waitcnt vmcnt(9) lgkmcnt(0)
    s_barrier
    v_mfma_f32_16x16x32_bf16 v[204:207], v[60:63], v[28:31], v[204:207]
    ds_read_b64_tr_b16 v[72:73], v5 offset:26688
    v_mfma_f32_16x16x32_bf16 v[200:203], v[60:63], v[24:27], v[200:203]
    ds_read_b64_tr_b16 v[74:75], v5 offset:28480
    v_mfma_f32_16x16x32_bf16 v[196:199], v[60:63], v[20:23], v[196:199]
    ds_read_b64_tr_b16 v[76:77], v5 offset:26720
    v_mfma_f32_16x16x32_bf16 v[192:195], v[60:63], v[16:19], v[192:195]
    ds_read_b64_tr_b16 v[78:79], v5 offset:28512
    v_mfma_f32_16x16x32_bf16 v[208:211], v[64:67], v[16:19], v[208:211]
    ds_read_b64_tr_b16 v[48:49], v5 offset:26752
    v_mfma_f32_16x16x32_bf16 v[212:215], v[64:67], v[20:23], v[212:215]
    ds_read_b64_tr_b16 v[50:51], v5 offset:28544
    v_mfma_f32_16x16x32_bf16 v[216:219], v[64:67], v[24:27], v[216:219]
    ds_read_b64_tr_b16 v[52:53], v5 offset:26784
    v_mfma_f32_16x16x32_bf16 v[220:223], v[64:67], v[28:31], v[220:223]
    ds_read_b64_tr_b16 v[54:55], v5 offset:28576
    v_mfma_f32_16x16x32_bf16 v[236:239], v[68:71], v[28:31], v[236:239]
    ds_read_b64_tr_b16 v[56:57], v5 offset:26816
    v_mfma_f32_16x16x32_bf16 v[232:235], v[68:71], v[24:27], v[232:235]
    ds_read_b64_tr_b16 v[58:59], v5 offset:28608
    v_mfma_f32_16x16x32_bf16 v[228:231], v[68:71], v[20:23], v[228:231]
    v_mfma_f32_16x16x32_bf16 v[224:227], v[68:71], v[16:19], v[224:227]
    s_waitcnt lgkmcnt(8)
    v_mfma_f32_16x16x32_bf16 v[80:83], v[72:75], v[32:35], v[80:83]
    ds_read_b64_tr_b16 v[60:61], v5 offset:33856
    v_mfma_f32_16x16x32_bf16 v[84:87], v[72:75], v[36:39], v[84:87]
    ds_read_b64_tr_b16 v[62:63], v5 offset:35648
    v_mfma_f32_16x16x32_bf16 v[88:91], v[72:75], v[40:43], v[88:91]
    s_add_u32 m0, s56, 32768
    s_add_u32 s60, s55, 0
    buffer_load_dwordx4 v10, s[28:31], s60 offen lds
    v_mfma_f32_16x16x32_bf16 v[92:95], v[72:75], v[44:47], v[92:95]
    s_waitcnt lgkmcnt(8)
    v_mfma_f32_16x16x32_bf16 v[108:111], v[76:79], v[44:47], v[108:111]
    ds_read_b64_tr_b16 v[64:65], v5 offset:33888
    v_mfma_f32_16x16x32_bf16 v[104:107], v[76:79], v[40:43], v[104:107]
    ds_read_b64_tr_b16 v[66:67], v5 offset:35680
    v_mfma_f32_16x16x32_bf16 v[100:103], v[76:79], v[36:39], v[100:103]
    s_add_u32 m0, s56, 33792
    s_add_u32 s60, s55, 16384
    buffer_load_dwordx4 v10, s[28:31], s60 offen lds
    v_mfma_f32_16x16x32_bf16 v[96:99], v[76:79], v[32:35], v[96:99]
    s_waitcnt lgkmcnt(8)
    v_mfma_f32_16x16x32_bf16 v[112:115], v[48:51], v[32:35], v[112:115]
    ds_read_b64_tr_b16 v[68:69], v5 offset:33920
    v_mfma_f32_16x16x32_bf16 v[116:119], v[48:51], v[36:39], v[116:119]
    ds_read_b64_tr_b16 v[70:71], v5 offset:35712
    v_mfma_f32_16x16x32_bf16 v[120:123], v[48:51], v[40:43], v[120:123]
    s_add_u32 m0, s56, 34816
    s_add_u32 s60, s55, 32768
    buffer_load_dwordx4 v10, s[28:31], s60 offen lds
    v_mfma_f32_16x16x32_bf16 v[124:127], v[48:51], v[44:47], v[124:127]
    s_waitcnt lgkmcnt(8)
    v_mfma_f32_16x16x32_bf16 v[140:143], v[52:55], v[44:47], v[140:143]
    ds_read_b64_tr_b16 v[72:73], v5 offset:33952
    v_mfma_f32_16x16x32_bf16 v[136:139], v[52:55], v[40:43], v[136:139]
    ds_read_b64_tr_b16 v[74:75], v5 offset:35744
    v_mfma_f32_16x16x32_bf16 v[132:135], v[52:55], v[36:39], v[132:135]
    s_add_u32 m0, s56, 35840
    s_add_u32 s60, s55, 49152
    buffer_load_dwordx4 v10, s[28:31], s60 offen lds
    v_mfma_f32_16x16x32_bf16 v[128:131], v[52:55], v[32:35], v[128:131]
    s_waitcnt lgkmcnt(8)
    v_mfma_f32_16x16x32_bf16 v[144:147], v[56:59], v[32:35], v[144:147]
    ds_read_b64_tr_b16 v[76:77], v5 offset:33984
    v_mfma_f32_16x16x32_bf16 v[148:151], v[56:59], v[36:39], v[148:151]
    ds_read_b64_tr_b16 v[78:79], v5 offset:35776
    v_mfma_f32_16x16x32_bf16 v[152:155], v[56:59], v[40:43], v[152:155]
    s_add_u32 m0, s56, 36864
    s_add_u32 s60, s55, 65536
    buffer_load_dwordx4 v10, s[28:31], s60 offen lds
    s_add_u32 s55, s55, 128
    v_mfma_f32_16x16x32_bf16 v[156:159], v[56:59], v[44:47], v[156:159]
    s_waitcnt lgkmcnt(8)
    v_mfma_f32_16x16x32_bf16 v[172:175], v[60:63], v[44:47], v[172:175]
    s_add_u32 m0, s54, 40960
    s_nop 0
    buffer_load_dwordx4 v11, s[32:35], s52 offen lds
    v_mfma_f32_16x16x32_bf16 v[168:171], v[60:63], v[40:43], v[168:171]
    v_mfma_f32_16x16x32_bf16 v[164:167], v[60:63], v[36:39], v[164:167]
    v_mfma_f32_16x16x32_bf16 v[160:163], v[60:63], v[32:35], v[160:163]
    s_waitcnt lgkmcnt(6)
    v_mfma_f32_16x16x32_bf16 v[176:179], v[64:67], v[32:35], v[176:179]
    s_add_u32 m0, s54, 41984
    s_nop 0
    buffer_load_dwordx4 v12, s[36:39], s52 offen lds
    s_add_u32 s52, s52, s53
    v_mfma_f32_16x16x32_bf16 v[180:183], v[64:67], v[36:39], v[180:183]
    v_mfma_f32_16x16x32_bf16 v[184:187], v[64:67], v[40:43], v[184:187]
    v_mfma_f32_16x16x32_bf16 v[188:191], v[64:67], v[44:47], v[188:191]
    s_waitcnt vmcnt(9) lgkmcnt(0)
    s_barrier
    v_mfma_f32_16x16x32_bf16 v[204:207], v[68:71], v[44:47], v[204:207]
    ds_read_b64_tr_b16 v[48:49], v4 offset:6208
    ds_read_b64_tr_b16 v[50:51], v4 offset:8000
    v_mfma_f32_16x16x32_bf16 v[200:203], v[68:71], v[40:43], v[200:203]
    ds_read_b128 v[16:19], v2 offset:0
    v_mfma_f32_16x16x32_bf16 v[196:199], v[68:71], v[36:39], v[196:199]
    ds_read_b128 v[20:23], v2 offset:2048
    v_mfma_f32_16x16x32_bf16 v[192:195], v[68:71], v[32:35], v[192:195]
    ds_read_b128 v[24:27], v2 offset:4096
    v_mfma_f32_16x16x32_bf16 v[208:211], v[72:75], v[32:35], v[208:211]
    ds_read_b128 v[28:31], v2 offset:6144
    ds_read_b64_tr_b16 v[52:53], v4 offset:6240
    v_mfma_f32_16x16x32_bf16 v[212:215], v[72:75], v[36:39], v[212:215]
    ds_read_b64_tr_b16 v[54:55], v4 offset:8032
    v_mfma_f32_16x16x32_bf16 v[216:219], v[72:75], v[40:43], v[216:219]
    ds_read_b64_tr_b16 v[56:57], v4 offset:6272
    v_mfma_f32_16x16x32_bf16 v[220:223], v[72:75], v[44:47], v[220:223]
    ds_read_b64_tr_b16 v[58:59], v4 offset:8064
    v_mfma_f32_16x16x32_bf16 v[236:239], v[76:79], v[44:47], v[236:239]
    ds_read_b64_tr_b16 v[60:61], v4 offset:6304
    v_mfma_f32_16x16x32_bf16 v[232:235], v[76:79], v[40:43], v[232:235]
    ds_read_b64_tr_b16 v[62:63], v4 offset:8096
    v_mfma_f32_16x16x32_bf16 v[228:231], v[76:79], v[36:39], v[228:231]
    ds_read_b64_tr_b16 v[64:65], v4 offset:6336
    v_mfma_f32_16x16x32_bf16 v[224:227], v[76:79], v[32:35], v[224:227]
    ds_read_b64_tr_b16 v[66:67], v4 offset:8128
    s_sub_u32 s57, s57, 1
    s_branch L_loop1
L_tail1:
    s_mov_b32 s52, 3216550459
    s_mov_b32 s54, 1.0
    s_mov_b32 s53, 3216550459
    s_mov_b32 s55, 1.0
    s_mul_i32 s27, s24, 24576
    s_add_u32 s27, s27, 270336
    s_add_u32 s27, s27, s26
    ds_read_b128 v[16:19], v2 offset:32768
    ds_read_b128 v[20:23], v2 offset:34816
    ds_read_b128 v[24:27], v2 offset:36864
    ds_read_b128 v[28:31], v2 offset:38912
    v_mfma_f32_16x16x32_bf16 v[192:195], v[52:55], v[32:35], v[192:195]
    ds_read_b64_tr_b16 v[64:65], v5 offset:6208
    ds_read_b64_tr_b16 v[66:67], v5 offset:8000
    v_mfma_f32_16x16x32_bf16 v[196:199], v[52:55], v[36:39], v[196:199]
    ds_read_b64_tr_b16 v[68:69], v5 offset:13376
    ds_read_b64_tr_b16 v[70:71], v5 offset:15168
    v_mfma_f32_16x16x32_bf16 v[200:203], v[52:55], v[40:43], v[200:203]
    ds_read_b64_tr_b16 v[72:73], v5 offset:26688
    ds_read_b64_tr_b16 v[74:75], v5 offset:28480
    v_mfma_f32_16x16x32_bf16 v[204:207], v[52:55], v[44:47], v[204:207]
    ds_read_b64_tr_b16 v[76:77], v5 offset:33856
    ds_read_b64_tr_b16 v[78:79], v5 offset:35648
    v_mfma_f32_16x16x32_bf16 v[220:223], v[56:59], v[44:47], v[220:223]
    v_mfma_f32_16x16x32_bf16 v[216:219], v[56:59], v[40:43], v[216:219]
    v_mfma_f32_16x16x32_bf16 v[212:215], v[56:59], v[36:39], v[212:215]
    ds_read_b64_tr_b16 v[48:49], v5 offset:6240
    ds_read_b64_tr_b16 v[50:51], v5 offset:8032
    v_mfma_f32_16x16x32_bf16 v[208:211], v[56:59], v[32:35], v[208:211]
    v_mfma_f32_16x16x32_bf16 v[224:227], v[60:63], v[32:35], v[224:227]
    v_mfma_f32_16x16x32_bf16 v[228:231], v[60:63], v[36:39], v[228:231]
    v_mfma_f32_16x16x32_bf16 v[232:235], v[60:63], v[40:43], v[232:235]
    ds_read_b64_tr_b16 v[52:53], v5 offset:13408
    ds_read_b64_tr_b16 v[54:55], v5 offset:15200
    v_mfma_f32_16x16x32_bf16 v[236:239], v[60:63], v[44:47], v[236:239]
    s_waitcnt lgkmcnt(10)
    v_mfma_f32_16x16x32_bf16 v[92:95], v[64:67], v[28:31], v[92:95]
    ds_read_b128 v[32:35], v3 offset:32768
    v_mfma_f32_16x16x32_bf16 v[88:91], v[64:67], v[24:27], v[88:91]
    ds_read_b128 v[36:39], v3 offset:34816
    v_mfma_f32_16x16x32_bf16 v[84:87], v[64:67], v[20:23], v[84:87]
    ds_read_b128 v[40:43], v3 offset:36864
    v_mfma_f32_16x16x32_bf16 v[80:83], v[64:67], v[16:19], v[80:83]
    ds_read_b128 v[44:47], v3 offset:38912
    s_waitcnt lgkmcnt(12)
    v_mfma_f32_16x16x32_bf16 v[160:163], v[68:71], v[16:19], v[160:163]
    ds_read_b64_tr_b16 v[56:57], v5 offset:26720
    ds_read_b64_tr_b16 v[58:59], v5 offset:28512
    v_mfma_f32_16x16x32_bf16 v[164:167], v[68:71], v[20:23], v[164:167]
    v_mfma_f32_16x16x32_bf16 v[168:171], v[68:71], v[24:27], v[168:171]
    v_mfma_f32_16x16x32_bf16 v[172:175], v[68:71], v[28:31], v[172:175]
    s_waitcnt lgkmcnt(2)
    v_mfma_f32_16x16x32_bf16 v[92:95], v[72:75], v[44:47], v[92:95]
    ds_read_b64_tr_b16 v[60:61], v5 offset:33888
    ds_read_b64_tr_b16 v[62:63], v5 offset:35680
    v_mfma_f32_16x16x32_bf16 v[88:91], v[72:75], v[40:43], v[88:91]
    v_mfma_f32_16x16x32_bf16 v[84:87], v[72:75], v[36:39], v[84:87]
    v_mfma_f32_16x16x32_bf16 v[80:83], v[72:75], v[32:35], v[80:83]
    v_mfma_f32_16x16x32_bf16 v[160:163], v[76:79], v[32:35], v[160:163]
    ds_read_b64_tr_b16 v[64:65], v5 offset:6272
    ds_read_b64_tr_b16 v[66:67], v5 offset:8064
    v_mfma_f32_16x16x32_bf16 v[164:167], v[76:79], v[36:39], v[164:167]
    v_mfma_f32_16x16x32_bf16 v[168:171], v[76:79], v[40:43], v[168:171]
    v_mfma_f32_16x16x32_bf16 v[172:175], v[76:79], v[44:47], v[172:175]
    v_mfma_f32_16x16x32_bf16 v[108:111], v[48:51], v[28:31], v[108:111]
    ds_read_b64_tr_b16 v[68:69], v5 offset:13440
    ds_read_b64_tr_b16 v[70:71], v5 offset:15232
    v_mfma_f32_16x16x32_bf16 v[104:107], v[48:51], v[24:27], v[104:107]
    v_mfma_f32_16x16x32_bf16 v[100:103], v[48:51], v[20:23], v[100:103]
    v_mul_f32 v80, v80, s52
    v_mul_f32 v81, v81, s53
    v_exp_f32 v80, v80
    v_mfma_f32_16x16x32_bf16 v[96:99], v[48:51], v[16:19], v[96:99]
    v_mul_f32 v82, v82, s52
    v_exp_f32 v81, v81
    v_mul_f32 v83, v83, s53
    v_mfma_f32_16x16x32_bf16 v[176:179], v[52:55], v[16:19], v[176:179]
    ds_read_b64_tr_b16 v[72:73], v5 offset:26752
    ds_read_b64_tr_b16 v[74:75], v5 offset:28544
    v_exp_f32 v82, v82
    v_mul_f32 v84, v84, s52
    v_exp_f32 v83, v83
    v_mfma_f32_16x16x32_bf16 v[180:183], v[52:55], v[20:23], v[180:183]
    v_mul_f32 v85, v85, s53
    v_exp_f32 v84, v84
    v_mul_f32 v86, v86, s52
    v_mfma_f32_16x16x32_bf16 v[184:187], v[52:55], v[24:27], v[184:187]
    v_exp_f32 v85, v85
    v_mul_f32 v87, v87, s53
    v_exp_f32 v86, v86
    v_mfma_f32_16x16x32_bf16 v[188:191], v[52:55], v[28:31], v[188:191]
    v_mul_f32 v88, v88, s52
    v_exp_f32 v87, v87
    v_mul_f32 v89, v89, s53
    s_waitcnt lgkmcnt(8)
    v_mfma_f32_16x16x32_bf16 v[108:111], v[56:59], v[44:47], v[108:111]
    ds_read_b64_tr_b16 v[76:77], v5 offset:33920
    ds_read_b64_tr_b16 v[78:79], v5 offset:35712
    v_exp_f32 v88, v88
    v_mul_f32 v90, v90, s52
    v_exp_f32 v89, v89
    v_mfma_f32_16x16x32_bf16 v[104:107], v[56:59], v[40:43], v[104:107]
    v_mul_f32 v91, v91, s53
    v_exp_f32 v90, v90
    v_mul_f32 v92, v92, s52
    v_mfma_f32_16x16x32_bf16 v[100:103], v[56:59], v[36:39], v[100:103]
    v_exp_f32 v91, v91
    v_mul_f32 v93, v93, s53
    v_exp_f32 v92, v92
    v_mfma_f32_16x16x32_bf16 v[96:99], v[56:59], v[32:35], v[96:99]
    v_mul_f32 v94, v94, s52
    v_exp_f32 v93, v93
    v_mul_f32 v95, v95, s53
    s_waitcnt lgkmcnt(8)
    v_mfma_f32_16x16x32_bf16 v[176:179], v[60:63], v[32:35], v[176:179]
    ds_read_b64_tr_b16 v[48:49], v5 offset:6304
    ds_read_b64_tr_b16 v[50:51], v5 offset:8096
    v_exp_f32 v94, v94
    v_add_f32 v80, v80, s54
    v_exp_f32 v95, v95
    v_mfma_f32_16x16x32_bf16 v[180:183], v[60:63], v[36:39], v[180:183]
    v_add_f32 v81, v81, s55
    v_rcp_f32 v80, v80
    v_add_f32 v82, v82, s54
    v_mfma_f32_16x16x32_bf16 v[184:187], v[60:63], v[40:43], v[184:187]
    v_rcp_f32 v81, v81
    v_add_f32 v83, v83, s55
    v_rcp_f32 v82, v82
    v_mfma_f32_16x16x32_bf16 v[188:191], v[60:63], v[44:47], v[188:191]
    v_add_f32 v84, v84, s54
    v_rcp_f32 v83, v83
    v_add_f32 v85, v85, s55
    s_waitcnt lgkmcnt(8)
    v_mfma_f32_16x16x32_bf16 v[124:127], v[64:67], v[28:31], v[124:127]
    ds_read_b64_tr_b16 v[52:53], v5 offset:13472
    ds_read_b64_tr_b16 v[54:55], v5 offset:15264
    v_rcp_f32 v84, v84
    v_add_f32 v86, v86, s54
    v_rcp_f32 v85, v85
    v_mfma_f32_16x16x32_bf16 v[120:123], v[64:67], v[24:27], v[120:123]
    v_add_f32 v87, v87, s55
    v_rcp_f32 v86, v86
    v_add_f32 v88, v88, s54
    v_mfma_f32_16x16x32_bf16 v[116:119], v[64:67], v[20:23], v[116:119]
    v_rcp_f32 v87, v87
    v_add_f32 v89, v89, s55
    v_rcp_f32 v88, v88
    v_mfma_f32_16x16x32_bf16 v[112:115], v[64:67], v[16:19], v[112:115]
    v_add_f32 v90, v90, s54
    v_rcp_f32 v89, v89
    v_add_f32 v91, v91, s55
    s_waitcnt lgkmcnt(8)
    v_mfma_f32_16x16x32_bf16 v[192:195], v[68:71], v[16:19], v[192:195]
    ds_read_b64_tr_b16 v[56:57], v5 offset:26784
    ds_read_b64_tr_b16 v[58:59], v5 offset:28576
    v_rcp_f32 v90, v90
    v_add_f32 v92, v92, s54
    v_rcp_f32 v91, v91
    v_mfma_f32_16x16x32_bf16 v[196:199], v[68:71], v[20:23], v[196:199]
    v_add_f32 v93, v93, s55
    v_rcp_f32 v92, v92
    v_add_f32 v94, v94, s54
    v_mfma_f32_16x16x32_bf16 v[200:203], v[68:71], v[24:27], v[200:203]
    v_rcp_f32 v93, v93
    v_add_f32 v95, v95, s55
    v_rcp_f32 v94, v94
    v_mfma_f32_16x16x32_bf16 v[204:207], v[68:71], v[28:31], v[204:207]
    v_mul_f32 v160, v160, v80
    v_rcp_f32 v95, v95
    v_mul_f32 v161, v161, v81
    s_waitcnt lgkmcnt(8)
    v_mfma_f32_16x16x32_bf16 v[124:127], v[72:75], v[44:47], v[124:127]
    ds_read_b64_tr_b16 v[60:61], v5 offset:33952
    ds_read_b64_tr_b16 v[62:63], v5 offset:35744
    v_mul_f32 v162, v162, v82
    v_mul_f32 v163, v163, v83
    v_mul_f32 v164, v164, v84
    v_mfma_f32_16x16x32_bf16 v[120:123], v[72:75], v[40:43], v[120:123]
    v_mul_f32 v165, v165, v85
    v_mul_f32 v166, v166, v86
    v_mul_f32 v167, v167, v87
    v_mfma_f32_16x16x32_bf16 v[116:119], v[72:75], v[36:39], v[116:119]
    v_mul_f32 v168, v168, v88
    v_mul_f32 v169, v169, v89
    v_mul_f32 v170, v170, v90
    v_mfma_f32_16x16x32_bf16 v[112:115], v[72:75], v[32:35], v[112:115]
    v_mul_f32 v171, v171, v91
    v_mul_f32 v172, v172, v92
    v_mul_f32 v173, v173, v93
    s_waitcnt lgkmcnt(8)
    v_mfma_f32_16x16x32_bf16 v[192:195], v[76:79], v[32:35], v[192:195]
    ds_read_b64_tr_b16 v[64:65], v5 offset:6336
    ds_read_b64_tr_b16 v[66:67], v5 offset:8128
    v_mul_f32 v174, v174, v94
    v_mul_f32 v175, v175, v95
    v_mul_f32 v96, v96, s52
    v_mfma_f32_16x16x32_bf16 v[196:199], v[76:79], v[36:39], v[196:199]
    v_mul_f32 v97, v97, s53
    v_exp_f32 v96, v96
    v_mul_f32 v98, v98, s52
    v_mfma_f32_16x16x32_bf16 v[200:203], v[76:79], v[40:43], v[200:203]
    v_exp_f32 v97, v97
    v_mul_f32 v99, v99, s53
    v_exp_f32 v98, v98
    v_mfma_f32_16x16x32_bf16 v[204:207], v[76:79], v[44:47], v[204:207]
    v_mul_f32 v100, v100, s52
    v_exp_f32 v99, v99
    v_mul_f32 v101, v101, s53
    s_waitcnt lgkmcnt(8)
    v_mfma_f32_16x16x32_bf16 v[140:143], v[48:51], v[28:31], v[140:143]
    ds_read_b64_tr_b16 v[68:69], v5 offset:13504
    ds_read_b64_tr_b16 v[70:71], v5 offset:15296
    v_exp_f32 v100, v100
    v_mul_f32 v102, v102, s52
    v_exp_f32 v101, v101
    v_mfma_f32_16x16x32_bf16 v[136:139], v[48:51], v[24:27], v[136:139]
    v_mul_f32 v103, v103, s53
    v_exp_f32 v102, v102
    v_mul_f32 v104, v104, s52
    v_mfma_f32_16x16x32_bf16 v[132:135], v[48:51], v[20:23], v[132:135]
    v_exp_f32 v103, v103
    v_mul_f32 v105, v105, s53
    v_exp_f32 v104, v104
    v_mfma_f32_16x16x32_bf16 v[128:131], v[48:51], v[16:19], v[128:131]
    v_mul_f32 v106, v106, s52
    v_exp_f32 v105, v105
    v_mul_f32 v107, v107, s53
    s_waitcnt lgkmcnt(8)
    v_mfma_f32_16x16x32_bf16 v[208:211], v[52:55], v[16:19], v[208:211]
    ds_read_b64_tr_b16 v[72:73], v5 offset:26816
    ds_read_b64_tr_b16 v[74:75], v5 offset:28608
    v_exp_f32 v106, v106
    v_mul_f32 v108, v108, s52
    v_exp_f32 v107, v107
    v_mfma_f32_16x16x32_bf16 v[212:215], v[52:55], v[20:23], v[212:215]
    v_mul_f32 v109, v109, s53
    v_exp_f32 v108, v108
    v_mul_f32 v110, v110, s52
    v_mfma_f32_16x16x32_bf16 v[216:219], v[52:55], v[24:27], v[216:219]
    v_exp_f32 v109, v109
    v_mul_f32 v111, v111, s53
    v_exp_f32 v110, v110
    v_mfma_f32_16x16x32_bf16 v[220:223], v[52:55], v[28:31], v[220:223]
    v_add_f32 v96, v96, s54
    v_exp_f32 v111, v111
    v_add_f32 v97, v97, s55
    s_waitcnt lgkmcnt(8)
    v_mfma_f32_16x16x32_bf16 v[140:143], v[56:59], v[44:47], v[140:143]
    ds_read_b64_tr_b16 v[76:77], v5 offset:33984
    ds_read_b64_tr_b16 v[78:79], v5 offset:35776
    v_rcp_f32 v96, v96
    v_add_f32 v98, v98, s54
    v_rcp_f32 v97, v97
    v_mfma_f32_16x16x32_bf16 v[136:139], v[56:59], v[40:43], v[136:139]
    v_add_f32 v99, v99, s55
    v_rcp_f32 v98, v98
    v_add_f32 v100, v100, s54
    v_mfma_f32_16x16x32_bf16 v[132:135], v[56:59], v[36:39], v[132:135]
    v_rcp_f32 v99, v99
    v_add_f32 v101, v101, s55
    v_rcp_f32 v100, v100
    v_mfma_f32_16x16x32_bf16 v[128:131], v[56:59], v[32:35], v[128:131]
    v_add_f32 v102, v102, s54
    v_rcp_f32 v101, v101
    v_add_f32 v103, v103, s55
    s_waitcnt lgkmcnt(8)
    v_mfma_f32_16x16x32_bf16 v[208:211], v[60:63], v[32:35], v[208:211]
    v_rcp_f32 v102, v102
    v_add_f32 v104, v104, s54
    v_rcp_f32 v103, v103
    v_mfma_f32_16x16x32_bf16 v[212:215], v[60:63], v[36:39], v[212:215]
    v_add_f32 v105, v105, s55
    v_rcp_f32 v104, v104
    v_add_f32 v106, v106, s54
    v_mfma_f32_16x16x32_bf16 v[216:219], v[60:63], v[40:43], v[216:219]
    v_rcp_f32 v105, v105
    v_add_f32 v107, v107, s55
    v_rcp_f32 v106, v106
    v_mfma_f32_16x16x32_bf16 v[220:223], v[60:63], v[44:47], v[220:223]
    v_add_f32 v108, v108, s54
    v_rcp_f32 v107, v107
    v_add_f32 v109, v109, s55
    s_waitcnt lgkmcnt(6)
    v_mfma_f32_16x16x32_bf16 v[156:159], v[64:67], v[28:31], v[156:159]
    v_rcp_f32 v108, v108
    v_add_f32 v110, v110, s54
    v_rcp_f32 v109, v109
    v_mfma_f32_16x16x32_bf16 v[152:155], v[64:67], v[24:27], v[152:155]
    v_add_f32 v111, v111, s55
    v_rcp_f32 v110, v110
    v_mul_f32 v176, v176, v96
    v_mfma_f32_16x16x32_bf16 v[148:151], v[64:67], v[20:23], v[148:151]
    v_rcp_f32 v111, v111
    v_mul_f32 v177, v177, v97
    v_mul_f32 v178, v178, v98
    v_mfma_f32_16x16x32_bf16 v[144:147], v[64:67], v[16:19], v[144:147]
    v_mul_f32 v179, v179, v99
    v_mul_f32 v180, v180, v100
    v_mul_f32 v181, v181, v101
    s_waitcnt lgkmcnt(4)
    v_mfma_f32_16x16x32_bf16 v[224:227], v[68:71], v[16:19], v[224:227]
    v_mul_f32 v182, v182, v102
    v_mul_f32 v183, v183, v103
    v_mul_f32 v184, v184, v104
    v_mfma_f32_16x16x32_bf16 v[228:231], v[68:71], v[20:23], v[228:231]
    v_mul_f32 v185, v185, v105
    v_mul_f32 v186, v186, v106
    v_mul_f32 v187, v187, v107
    v_mfma_f32_16x16x32_bf16 v[232:235], v[68:71], v[24:27], v[232:235]
    v_mul_f32 v188, v188, v108
    v_mul_f32 v189, v189, v109
    v_mul_f32 v190, v190, v110
    v_mfma_f32_16x16x32_bf16 v[236:239], v[68:71], v[28:31], v[236:239]
    v_mul_f32 v191, v191, v111
    v_cvt_pk_bf16_f32 v80, v160, v161
    v_cvt_pk_bf16_f32 v81, v162, v163
    s_waitcnt lgkmcnt(2)
    v_mfma_f32_16x16x32_bf16 v[156:159], v[72:75], v[44:47], v[156:159]
    v_cvt_pk_bf16_f32 v82, v176, v177
    v_cvt_pk_bf16_f32 v83, v178, v179
    buffer_store_dwordx4 v[80:83], v15, s[44:47], s27 offen offset:0
    v_mfma_f32_16x16x32_bf16 v[152:155], v[72:75], v[40:43], v[152:155]
    v_cvt_pk_bf16_f32 v84, v164, v165
    v_cvt_pk_bf16_f32 v85, v166, v167
    v_cvt_pk_bf16_f32 v86, v180, v181
    v_mfma_f32_16x16x32_bf16 v[148:151], v[72:75], v[36:39], v[148:151]
    v_cvt_pk_bf16_f32 v87, v182, v183
    buffer_store_dwordx4 v[84:87], v15, s[44:47], s27 offen offset:1024
    v_cvt_pk_bf16_f32 v88, v168, v169
    v_mfma_f32_16x16x32_bf16 v[144:147], v[72:75], v[32:35], v[144:147]
    v_cvt_pk_bf16_f32 v89, v170, v171
    v_cvt_pk_bf16_f32 v90, v184, v185
    v_cvt_pk_bf16_f32 v91, v186, v187
    s_waitcnt lgkmcnt(0)
    v_mfma_f32_16x16x32_bf16 v[224:227], v[76:79], v[32:35], v[224:227]
    buffer_store_dwordx4 v[88:91], v15, s[44:47], s27 offen offset:2048
    v_cvt_pk_bf16_f32 v92, v172, v173
    v_cvt_pk_bf16_f32 v93, v174, v175
    v_mfma_f32_16x16x32_bf16 v[228:231], v[76:79], v[36:39], v[228:231]
    v_cvt_pk_bf16_f32 v94, v188, v189
    v_cvt_pk_bf16_f32 v95, v190, v191
    buffer_store_dwordx4 v[92:95], v15, s[44:47], s27 offen offset:3072
    v_mfma_f32_16x16x32_bf16 v[232:235], v[76:79], v[40:43], v[232:235]
    v_mul_f32 v112, v112, s52
    v_mul_f32 v113, v113, s53
    v_exp_f32 v112, v112
    v_mfma_f32_16x16x32_bf16 v[236:239], v[76:79], v[44:47], v[236:239]
    v_mul_f32 v114, v114, s52
    v_exp_f32 v113, v113
    v_mul_f32 v115, v115, s53
    s_barrier
    v_exp_f32 v114, v114
    v_mul_f32 v116, v116, s52
    v_exp_f32 v115, v115
    v_mul_f32 v117, v117, s53
    v_exp_f32 v116, v116
    v_mul_f32 v118, v118, s52
    v_exp_f32 v117, v117
    v_mul_f32 v119, v119, s53
    v_exp_f32 v118, v118
    v_mul_f32 v120, v120, s52
    v_exp_f32 v119, v119
    v_mul_f32 v121, v121, s53
    v_exp_f32 v120, v120
    v_mul_f32 v122, v122, s52
    v_exp_f32 v121, v121
    v_mul_f32 v123, v123, s53
    v_exp_f32 v122, v122
    v_mul_f32 v124, v124, s52
    v_exp_f32 v123, v123
    v_mul_f32 v125, v125, s53
    v_exp_f32 v124, v124
    v_mul_f32 v126, v126, s52
    v_exp_f32 v125, v125
    v_mul_f32 v127, v127, s53
    v_exp_f32 v126, v126
    v_add_f32 v112, v112, s54
    v_exp_f32 v127, v127
    v_add_f32 v113, v113, s55
    v_rcp_f32 v112, v112
    v_add_f32 v114, v114, s54
    v_rcp_f32 v113, v113
    v_add_f32 v115, v115, s55
    v_rcp_f32 v114, v114
    v_add_f32 v116, v116, s54
    v_rcp_f32 v115, v115
    v_add_f32 v117, v117, s55
    v_rcp_f32 v116, v116
    v_add_f32 v118, v118, s54
    v_rcp_f32 v117, v117
    v_add_f32 v119, v119, s55
    v_rcp_f32 v118, v118
    v_add_f32 v120, v120, s54
    v_rcp_f32 v119, v119
    v_add_f32 v121, v121, s55
    v_rcp_f32 v120, v120
    v_add_f32 v122, v122, s54
    v_rcp_f32 v121, v121
    v_add_f32 v123, v123, s55
    v_rcp_f32 v122, v122
    v_add_f32 v124, v124, s54
    v_rcp_f32 v123, v123
    v_add_f32 v125, v125, s55
    v_rcp_f32 v124, v124
    v_add_f32 v126, v126, s54
    v_rcp_f32 v125, v125
    v_add_f32 v127, v127, s55
    v_rcp_f32 v126, v126
    v_mul_f32 v192, v192, v112
    v_rcp_f32 v127, v127
    v_mul_f32 v193, v193, v113
    v_mul_f32 v194, v194, v114
    v_mul_f32 v195, v195, v115
    v_mul_f32 v196, v196, v116
    v_mul_f32 v197, v197, v117
    v_mul_f32 v198, v198, v118
    v_mul_f32 v199, v199, v119
    v_mul_f32 v200, v200, v120
    v_mul_f32 v201, v201, v121
    v_mul_f32 v202, v202, v122
    v_mul_f32 v203, v203, v123
    v_mul_f32 v204, v204, v124
    v_mul_f32 v205, v205, v125
    v_mul_f32 v206, v206, v126
    v_mul_f32 v207, v207, v127
    s_nop 7
    s_setprio 3
    s_mov_b32 s52, 3216550459
    s_mov_b32 s54, 1.0
    s_mov_b32 s53, 3216550459
    s_mov_b32 s55, 1.0
    v_lshlrev_b32 v2, 4, v1
    s_mov_b32 s69, 0x40000
    s_waitcnt vmcnt(12)
L_tag1:
    v_cmp_eq_u32 vcc, 0, v247
    s_cbranch_vccz L_tag1_go
    s_sub_u32 s69, s69, 1
    s_cbranch_scc1 L_tag1_go
    buffer_load_ubyte v247, v248, s[4:7], 0 offen sc1
    s_waitcnt vmcnt(0)
    s_branch L_tag1
L_tag1_go:
    v_cmp_ne_u32 vcc, s82, v247
    s_lshl_b32 s60, s84, 3
    s_lshr_b32 s60, vcc_lo, s60
    s_and_b32 s60, s60, 0xff
    s_cselect_b32 s83, 0, 1
    s_mov_b64 s[48:49], s[74:75]
    s_lshl_b32 s64, s24, 3
    s_lshl_b32 s65, s22, 1
    s_add_u32 s64, s64, s65
    s_lshl_b32 s65, s64, 11
    v_and_b32 v9, 0x1f0, v2
    v_lshrrev_b32 v10, 5, v1
    v_lshl_add_u32 v10, v10, 11, v9
    s_waitcnt lgkmcnt(0)
    buffer_load_dwordx4 v[16:19], v10, s[28:31], s65 offen offset:0
    buffer_load_dwordx4 v[20:23], v10, s[28:31], s65 offen offset:512
    buffer_load_dwordx4 v[24:27], v10, s[28:31], s65 offen offset:1024
    buffer_load_dwordx4 v[28:31], v10, s[28:31], s65 offen offset:1536
    buffer_load_dwordx4 v[32:35], v9, s[48:51], 0 offen offset:0
    buffer_load_dwordx4 v[36:39], v9, s[48:51], 0 offen offset:512
    buffer_load_dwordx4 v[40:43], v9, s[48:51], 0 offen offset:1024
    buffer_load_dwordx4 v[44:47], v9, s[48:51], 0 offen offset:1536
    v_pk_mul_f32 v[128:129], v[128:129], s[52:53]
    v_pk_mul_f32 v[130:131], v[130:131], s[52:53]
    v_exp_f32 v128, v128
    v_pk_mul_f32 v[132:133], v[132:133], s[52:53]
    v_exp_f32 v129, v129
    v_pk_mul_f32 v[134:135], v[134:135], s[52:53]
    v_exp_f32 v130, v130
    s_mul_i32 s70, s24, 24576
    v_exp_f32 v131, v131
    v_pk_mul_f32 v[136:137], v[136:137], s[52:53]
    v_exp_f32 v132, v132
    v_pk_mul_f32 v[138:139], v[138:139], s[52:53]
    v_exp_f32 v133, v133
    v_pk_mul_f32 v[140:141], v[140:141], s[52:53]
    v_exp_f32 v134, v134
    v_pk_mul_f32 v[142:143], v[142:143], s[52:53]
    v_exp_f32 v135, v135
    v_pk_mul_f32 v[144:145], v[144:145], s[52:53]
    v_exp_f32 v136, v136
    v_pk_mul_f32 v[146:147], v[146:147], s[52:53]
    v_exp_f32 v137, v137
    s_add_u32 s70, s70, 278528
    v_exp_f32 v138, v138
    v_pk_mul_f32 v[148:149], v[148:149], s[52:53]
    v_exp_f32 v139, v139
    v_pk_mul_f32 v[150:151], v[150:151], s[52:53]
    v_exp_f32 v140, v140
    v_pk_mul_f32 v[152:153], v[152:153], s[52:53]
    v_exp_f32 v141, v141
    v_pk_mul_f32 v[154:155], v[154:155], s[52:53]
    v_exp_f32 v142, v142
    v_pk_mul_f32 v[156:157], v[156:157], s[52:53]
    v_exp_f32 v143, v143
    v_pk_mul_f32 v[158:159], v[158:159], s[52:53]
    v_exp_f32 v144, v144
    s_add_u32 s70, s70, s26
    v_exp_f32 v145, v145
    v_pk_add_f32 v[128:129], v[128:129], s[54:55]
    v_exp_f32 v146, v146
    v_pk_add_f32 v[130:131], v[130:131], s[54:55]
    v_exp_f32 v147, v147
    s_lshr_b32 s71, s24, 1
    v_exp_f32 v148, v148
    v_pk_add_f32 v[132:133], v[132:133], s[54:55]
    v_exp_f32 v149, v149
    v_pk_add_f32 v[134:135], v[134:135], s[54:55]
    v_exp_f32 v150, v150
    v_pk_add_f32 v[136:137], v[136:137], s[54:55]
    v_exp_f32 v151, v151
    v_pk_add_f32 v[138:139], v[138:139], s[54:55]
    v_exp_f32 v152, v152
    v_pk_add_f32 v[140:141], v[140:141], s[54:55]
    v_exp_f32 v153, v153
    v_pk_add_f32 v[142:143], v[142:143], s[54:55]
    v_exp_f32 v154, v154
    s_lshl_b32 s71, s71, 13
    v_exp_f32 v155, v155
    v_pk_add_f32 v[144:145], v[144:145], s[54:55]
    v_exp_f32 v156, v156
    v_pk_add_f32 v[146:147], v[146:147], s[54:55]
    v_exp_f32 v157, v157
    v_pk_add_f32 v[148:149], v[148:149], s[54:55]
    v_exp_f32 v158, v158
    v_pk_add_f32 v[150:151], v[150:151], s[54:55]
    v_exp_f32 v159, v159
    s_add_u32 s71, s71, 1048576
    v_rcp_f32 v128, v128
    v_pk_add_f32 v[152:153], v[152:153], s[54:55]
    v_rcp_f32 v129, v129
    v_pk_add_f32 v[154:155], v[154:155], s[54:55]
    v_rcp_f32 v130, v130
    v_pk_add_f32 v[156:157], v[156:157], s[54:55]
    v_rcp_f32 v131, v131
    v_pk_add_f32 v[158:159], v[158:159], s[54:55]
    v_rcp_f32 v132, v132
    v_pk_mul_f32 v[208:209], v[208:209], v[128:129]
    v_rcp_f32 v133, v133
    v_pk_mul_f32 v[210:211], v[210:211], v[130:131]
    v_rcp_f32 v134, v134
    s_add_u32 s71, s71, s26
    v_rcp_f32 v135, v135
    v_pk_mul_f32 v[212:213], v[212:213], v[132:133]
    v_rcp_f32 v136, v136
    s_and_b32 s63, s24, 1
    v_rcp_f32 v137, v137
    v_pk_mul_f32 v[214:215], v[214:215], v[134:135]
    v_rcp_f32 v138, v138
    v_cvt_pk_bf16_f32 v112, v192, v193
    v_rcp_f32 v139, v139
    v_pk_mul_f32 v[216:217], v[216:217], v[136:137]
    v_rcp_f32 v140, v140
    v_cvt_pk_bf16_f32 v113, v194, v195
    v_rcp_f32 v141, v141
    v_pk_mul_f32 v[218:219], v[218:219], v[138:139]
    v_rcp_f32 v142, v142
    v_cvt_pk_bf16_f32 v114, v208, v209
    v_rcp_f32 v143, v143
    v_pk_mul_f32 v[220:221], v[220:221], v[140:141]
    v_rcp_f32 v144, v144
    v_cvt_pk_bf16_f32 v115, v210, v211
    v_rcp_f32 v145, v145
    v_pk_mul_f32 v[222:223], v[222:223], v[142:143]
    v_rcp_f32 v146, v146
    v_cvt_pk_bf16_f32 v116, v196, v197
    v_rcp_f32 v147, v147
    v_cvt_pk_bf16_f32 v117, v198, v199
    v_rcp_f32 v148, v148
    v_cvt_pk_bf16_f32 v118, v212, v213
    v_rcp_f32 v149, v149
    v_cvt_pk_bf16_f32 v119, v214, v215
    v_rcp_f32 v150, v150
    s_lshl_b32 s63, s63, 3
    v_rcp_f32 v151, v151
    v_pk_mul_f32 v[224:225], v[224:225], v[144:145]
    v_rcp_f32 v152, v152
    v_pk_mul_f32 v[226:227], v[226:227], v[146:147]
    v_rcp_f32 v153, v153
    v_cvt_pk_bf16_f32 v120, v200, v201
    v_rcp_f32 v154, v154
    v_cvt_pk_bf16_f32 v121, v202, v203
    v_rcp_f32 v155, v155
    v_cvt_pk_bf16_f32 v122, v216, v217
    v_rcp_f32 v156, v156
    v_cvt_pk_bf16_f32 v123, v218, v219
    v_rcp_f32 v157, v157
    v_pk_mul_f32 v[228:229], v[228:229], v[148:149]
    v_rcp_f32 v158, v158
    v_pk_mul_f32 v[230:231], v[230:231], v[150:151]
    v_rcp_f32 v159, v159
    buffer_store_dwordx4 v[112:115], v2, s[44:47], s70 offen offset:0
    v_cvt_pk_bf16_f32 v124, v204, v205
    v_cvt_pk_bf16_f32 v125, v206, v207
    v_cvt_pk_bf16_f32 v126, v220, v221
    v_cvt_pk_bf16_f32 v127, v222, v223
    v_pk_mul_f32 v[232:233], v[232:233], v[152:153]
    v_pk_mul_f32 v[234:235], v[234:235], v[154:155]
    buffer_store_dwordx4 v[116:119], v2, s[44:47], s70 offen offset:1024
    s_add_u32 s71, s71, s63
    v_pk_mul_f32 v[236:237], v[236:237], v[156:157]
    v_pk_mul_f32 v[238:239], v[238:239], v[158:159]
    v_cvt_pk_bf16_f32 v144, v224, v225
    v_cvt_pk_bf16_f32 v145, v226, v227
    buffer_store_dwordx4 v[120:123], v2, s[44:47], s70 offen offset:2048
    v_cvt_pk_bf16_f32 v148, v228, v229
    v_cvt_pk_bf16_f32 v149, v230, v231
    buffer_store_dwordx4 v[124:127], v2, s[44:47], s70 offen offset:3072
    v_cvt_pk_bf16_f32 v152, v232, v233
    v_cvt_pk_bf16_f32 v153, v234, v235
    buffer_store_dwordx2 v[144:145], v2, s[44:47], s71 offen offset:0
    v_cvt_pk_bf16_f32 v156, v236, v237
    v_cvt_pk_bf16_f32 v157, v238, v239
    buffer_store_dwordx2 v[148:149], v2, s[44:47], s71 offen offset:1024
    buffer_store_dwordx2 v[152:153], v2, s[44:47], s71 offen offset:2048
    buffer_store_dwordx2 v[156:157], v2, s[44:47], s71 offen offset:3072
    s_setprio 0
    s_mov_b64 s[36:37], s[72:73]
    s_mov_b32 s38, 7340032
    s_mov_b64 s[76:77], s[10:11]
    s_mov_b32 s78, 2097152
    s_mov_b64 s[40:41], s[80:81]
    s_mov_b32 s42, 4194304
    s_mov_b64 s[48:49], s[74:75]
    v_lshrrev_b32 v14, 4, v1
    v_and_b32 v12, 15, v1
    s_and_b32 s64, s20, 1
    s_lshl_b32 s64, s64, 3
    v_lshl_or_b32 v13, v14, 1, s64
    v_xor_b32 v12, v12, v13
    v_lshlrev_b32 v12, 4, v12
    v_lshl_add_u32 v12, v14, 11, v12
    s_lshl_b32 s65, s85, 8
    v_add_u32 v13, s65, v12
    s_waitcnt vmcnt(0)
    s_barrier
    s_cmp_eq_u32 s20, 4
    s_cbranch_scc0 L_f2
    s_add_u32 s67, s3, 0x8000
    v_mov_b32 v254, 2
    s_mov_b64 exec, 1
    s_cmp_lg_u32 s83, 0
    s_cbranch_scc1 L_f2_s
    buffer_wbl2 sc1
    s_waitcnt vmcnt(0)
    buffer_store_dword v254, off, s[44:47], s67 sc1
    s_branch L_f2_e
L_f2_s:
    buffer_store_dword v254, off, s[44:47], s67
L_f2_e:
    s_mov_b64 exec, -1
L_f2:
    s_add_u32 m0, s91, 0
    s_add_u32 s62, s86, 0
    buffer_load_dwordx4 v13, s[36:39], s62 offen lds
    s_add_u32 m0, s91, 8192
    s_add_u32 s62, s86, 65536
    buffer_load_dwordx4 v13, s[36:39], s62 offen lds
    s_add_u32 m0, s91, 16384
    s_add_u32 s62, s86, 131072
    buffer_load_dwordx4 v13, s[36:39], s62 offen lds
    s_add_u32 m0, s91, 24576
    s_add_u32 s62, s86, 229376
    buffer_load_dwordx4 v13, s[36:39], s62 offen lds
    s_add_u32 m0, s91, 32768
    s_add_u32 s62, s86, 294912
    buffer_load_dwordx4 v13, s[36:39], s62 offen lds
    s_add_u32 m0, s91, 40960
    s_add_u32 s62, s86, 360448
    buffer_load_dwordx4 v13, s[36:39], s62 offen lds
    v_mov_b32 v8, 0
    v_mov_b32 v9, 0
    v_dot2_f32_bf16 v8, v16, v32, v8
    v_dot2_f32_bf16 v9, v17, v33, v9
    v_dot2_f32_bf16 v8, v18, v34, v8
    v_dot2_f32_bf16 v9, v19, v35, v9
    v_dot2_f32_bf16 v8, v20, v36, v8
    v_dot2_f32_bf16 v9, v21, v37, v9
    v_dot2_f32_bf16 v8, v22, v38, v8
    v_dot2_f32_bf16 v9, v23, v39, v9
    v_dot2_f32_bf16 v8, v24, v40, v8
    v_dot2_f32_bf16 v9, v25, v41, v9
    v_dot2_f32_bf16 v8, v26, v42, v8
    v_dot2_f32_bf16 v9, v27, v43, v9
    v_dot2_f32_bf16 v8, v28, v44, v8
    v_dot2_f32_bf16 v9, v29, v45, v9
    v_dot2_f32_bf16 v8, v30, v46, v8
    v_dot2_f32_bf16 v9, v31, v47, v9
    s_nop 2
    v_add_f32 v8, v8, v9
    s_nop 1
    v_add_f32_dpp v8, v8, v8 row_ror:1 row_mask:0xf bank_mask:0xf
    s_nop 1
    v_add_f32_dpp v8, v8, v8 row_ror:2 row_mask:0xf bank_mask:0xf
    s_nop 1
    v_add_f32_dpp v8, v8, v8 row_ror:4 row_mask:0xf bank_mask:0xf
    s_nop 1
    v_add_f32_dpp v8, v8, v8 row_ror:8 row_mask:0xf bank_mask:0xf
    v_mov_b32 v9, v8
    s_nop 1
    v_permlane16_swap_b32 v8, v9
    v_add_f32 v8, v8, v9
    s_mov_b32 s70, 0x42700000
    v_med3_f32 v8, v8, s70, -s70
    v_mul_f32 v8, s52, v8
    v_exp_f32 v248, v8
    s_nop 0
    v_add_f32 v250, 1.0, v248
    v_mov_b32 v249, v248
    v_rcp_f32 v250, v250
    s_nop 0
    v_mov_b32 v251, v250
    s_lshl_b32 s27, s23, 12
    s_lshl_b32 s65, s24, 7
    s_add_u32 s27, s27, s65
    s_lshl_b32 s65, s22, 5
    s_add_u32 s27, s27, s65
    s_add_u32 s27, s27, 18939904
    v_lshrrev_b32 v12, 5, v1
    v_lshlrev_b32 v12, 4, v12
    s_mov_b32 exec_lo, 1
    s_mov_b32 exec_hi, 1
    buffer_store_dwordx4 v[248:251], v12, s[44:47], s27 offen sc1
    s_mov_b64 exec, -1
    v_lshrrev_b32 v4, 4, v1
    v_lshlrev_b32 v5, 10, v4
    v_bfe_u32 v6, v1, 2, 2
    v_lshl_add_u32 v5, v6, 8, v5
    v_and_b32 v6, 3, v1
    v_lshl_add_u32 v5, v6, 3, v5
    v_add_u32 v5, 65536, v5
    v_bfe_u32 v3, v1, 2, 3
    s_add_u32 s64, s84, 0
    s_and_b32 s64, s64, 3
    s_lshl_b32 s64, s64, 1
    v_xor_b32 v7, s64, v3
    v_lshl_add_u32 v240, v7, 5, v5
    v_xor_b32 v241, 32, v240
    s_add_u32 s64, s84, 1
    s_and_b32 s64, s64, 3
    s_lshl_b32 s64, s64, 1
    v_xor_b32 v7, s64, v3
    v_lshl_add_u32 v242, v7, 5, v5
    v_xor_b32 v243, 32, v242
    s_add_u32 s64, s84, 2
    s_and_b32 s64, s64, 3
    s_lshl_b32 s64, s64, 1
    v_xor_b32 v7, s64, v3
    v_lshl_add_u32 v244, v7, 5, v5
    v_xor_b32 v245, 32, v244
    s_add_u32 s64, s84, 3
    s_and_b32 s64, s64, 3
    s_lshl_b32 s64, s64, 1
    v_xor_b32 v7, s64, v3
    v_lshl_add_u32 v246, v7, 5, v5
    v_xor_b32 v247, 32, v246
    v_and_b32 v15, 0xf0, v2
    v_and_b32 v7, 7, v1
    v_lshlrev_b32 v7, 8, v7
    v_lshl_add_u32 v7, v4, 4, v7
    v_lshrrev_b32 v4, 2, v1
    v_lshlrev_b32 v4, 6, v4
    v_lshl_add_u32 v4, v6, 3, v4
    v_add_u32 v4, 147456, v4
    s_lshl_b32 s64, s20, 11
    s_add_u32 s64, s64, 131072
    v_add_u32 v3, s64, v2
    s_lshr_b32 s64, s20, 2
    s_lshl_b32 s64, s64, 10
    s_bfe_u32 s65, s20, 0x10001
    s_lshl_b32 s65, s65, 3
    s_add_u32 s64, s64, s65
    s_add_u32 s64, s64, 49152
    v_add_u32 v6, s64, v2
    s_and_b32 s65, s20, 1
    s_lshl_b32 s65, s65, 11
    v_add_u32 v5, s65, v6
    v_lshrrev_b32 v10, 2, v1
    v_and_b32 v11, 6, v10
    v_lshlrev_b32 v11, 1, v11
    v_lshrrev_b32 v12, 3, v10
    v_lshl_or_b32 v11, v12, 1, v11
    v_and_b32 v12, 1, v10
    v_or_b32 v11, v11, v12
    v_and_b32 v12, 3, v1
    s_lshl_b32 s68, s22, 2
    v_or_b32 v12, s68, v12
    v_xor_b32 v11, v11, v12
    v_lshlrev_b32 v11, 3, v11
    v_lshl_add_u32 v14, v10, 7, v11
    v_and_b32 v11, 0x30, v1
    v_mov_b32 v72, 0x3f803f80
    v_mov_b32 v73, 0x3f803f80
    v_mov_b32 v74, 0x3f803f80
    v_mov_b32 v75, 0x3f803f80
    v_cmp_eq_u32 s[66:67], 0, v15
    s_waitcnt vmcnt(1)
    s_setprio 3
    s_barrier
    ds_read_b64_tr_b16 v[16:17], v14 offset:0
    ds_read_b64_tr_b16 v[18:19], v14 offset:2048
    ds_read_b128 v[80:83], v2 offset:32768
    ds_read_b128 v[84:87], v2 offset:33792
    s_add_u32 s63, s89, 0
    buffer_load_dwordx4 v[176:179], v2, s[44:47], s63 offen sc1
    ds_read_b64_tr_b16 v[20:21], v14 offset:4096
    ds_read_b64_tr_b16 v[22:23], v14 offset:6144
    ds_read_b128 v[88:91], v2 offset:34816
    ds_read_b128 v[92:95], v2 offset:35840
    buffer_load_dwordx4 v[180:183], v2, s[44:47], s63 offen offset:1024 sc1
    ds_read_b64_tr_b16 v[24:25], v14 offset:8192
    ds_read_b64_tr_b16 v[26:27], v14 offset:10240
    ds_read_b128 v[96:99], v2 offset:36864
    ds_read_b128 v[100:103], v2 offset:37888
    s_add_u32 s63, s89, 8192
    buffer_load_dwordx4 v[184:187], v2, s[44:47], s63 offen sc1
    ds_read_b64_tr_b16 v[28:29], v14 offset:12288
    ds_read_b64_tr_b16 v[30:31], v14 offset:14336
    ds_read_b128 v[104:107], v2 offset:38912
    ds_read_b128 v[108:111], v2 offset:39936
    buffer_load_dwordx4 v[188:191], v2, s[44:47], s63 offen offset:1024 sc1
    s_waitcnt lgkmcnt(12)
    v_mfma_f32_16x16x32_bf16 v[48:51], v[16:19], v[80:83], 0
    v_mfma_f32_16x16x32_bf16 v[52:55], v[16:19], v[84:87], 0
    v_mfma_f32_16x16x32_bf16 v[56:59], v[16:19], v[72:75], 0
    ds_read_b64_tr_b16 v[32:33], v14 offset:16384
    ds_read_b64_tr_b16 v[34:35], v14 offset:18432
    ds_read_b128 v[112:115], v2 offset:40960
    ds_read_b128 v[116:119], v2 offset:41984
    s_waitcnt lgkmcnt(12)
    v_mfma_f32_16x16x32_bf16 v[48:51], v[20:23], v[88:91], v[48:51]
    v_mfma_f32_16x16x32_bf16 v[52:55], v[20:23], v[92:95], v[52:55]
    v_mfma_f32_16x16x32_bf16 v[56:59], v[20:23], v[72:75], v[56:59]
    ds_read_b64_tr_b16 v[36:37], v14 offset:20480
    ds_read_b64_tr_b16 v[38:39], v14 offset:22528
    ds_read_b128 v[120:123], v2 offset:43008
    ds_read_b128 v[124:127], v2 offset:44032
    s_waitcnt lgkmcnt(12)
    v_mfma_f32_16x16x32_bf16 v[48:51], v[24:27], v[96:99], v[48:51]
    v_mfma_f32_16x16x32_bf16 v[52:55], v[24:27], v[100:103], v[52:55]
    v_mfma_f32_16x16x32_bf16 v[56:59], v[24:27], v[72:75], v[56:59]
    ds_read_b64_tr_b16 v[40:41], v14 offset:24576
    ds_read_b64_tr_b16 v[42:43], v14 offset:26624
    ds_read_b128 v[128:131], v2 offset:45056
    ds_read_b128 v[132:135], v2 offset:46080
    s_waitcnt lgkmcnt(12)
    v_mfma_f32_16x16x32_bf16 v[48:51], v[28:31], v[104:107], v[48:51]
    v_mfma_f32_16x16x32_bf16 v[52:55], v[28:31], v[108:111], v[52:55]
    v_mfma_f32_16x16x32_bf16 v[56:59], v[28:31], v[72:75], v[56:59]
    ds_read_b64_tr_b16 v[44:45], v14 offset:28672
    ds_read_b64_tr_b16 v[46:47], v14 offset:30720
    ds_read_b128 v[136:139], v2 offset:47104
    ds_read_b128 v[140:143], v2 offset:48128
    s_waitcnt lgkmcnt(12)
    v_mfma_f32_16x16x32_bf16 v[48:51], v[32:35], v[112:115], v[48:51]
    v_mfma_f32_16x16x32_bf16 v[52:55], v[32:35], v[116:119], v[52:55]
    v_mfma_f32_16x16x32_bf16 v[56:59], v[32:35], v[72:75], v[56:59]
    s_waitcnt lgkmcnt(8)
    v_mfma_f32_16x16x32_bf16 v[48:51], v[36:39], v[120:123], v[48:51]
    v_mfma_f32_16x16x32_bf16 v[52:55], v[36:39], v[124:127], v[52:55]
    v_mfma_f32_16x16x32_bf16 v[56:59], v[36:39], v[72:75], v[56:59]
    s_waitcnt lgkmcnt(4)
    v_mfma_f32_16x16x32_bf16 v[48:51], v[40:43], v[128:131], v[48:51]
    v_mfma_f32_16x16x32_bf16 v[52:55], v[40:43], v[132:135], v[52:55]
    v_mfma_f32_16x16x32_bf16 v[56:59], v[40:43], v[72:75], v[56:59]
    s_waitcnt lgkmcnt(0)
    v_mfma_f32_16x16x32_bf16 v[48:51], v[44:47], v[136:139], v[48:51]
    v_mfma_f32_16x16x32_bf16 v[52:55], v[44:47], v[140:143], v[52:55]
    v_mfma_f32_16x16x32_bf16 v[56:59], v[44:47], v[72:75], v[56:59]
    s_nop 5
    buffer_store_dwordx4 v[48:51], v2, s[44:47], s99 offen offset:0 sc1
    buffer_store_dwordx4 v[52:55], v2, s[44:47], s99 offen offset:1024 sc1
    s_mov_b64 exec, s[66:67]
    buffer_store_dwordx4 v[56:59], v11, s[44:47], s100 offen sc1
    s_mov_b64 exec, -1
    s_setprio 0
L_phase2:
    ds_read_b64_tr_b16 v[16:17], v240 offset:0
    ds_read_b64_tr_b16 v[18:19], v240 offset:4096
    ds_read_b64_tr_b16 v[20:21], v241 offset:0
    ds_read_b64_tr_b16 v[22:23], v241 offset:4096
    ds_read_b64_tr_b16 v[24:25], v242 offset:0
    ds_read_b64_tr_b16 v[26:27], v242 offset:4096
    ds_read_b64_tr_b16 v[28:29], v243 offset:0
    ds_read_b64_tr_b16 v[30:31], v243 offset:4096
    ds_read_b64_tr_b16 v[32:33], v244 offset:0
    ds_read_b64_tr_b16 v[34:35], v244 offset:4096
    ds_read_b64_tr_b16 v[36:37], v245 offset:0
    ds_read_b64_tr_b16 v[38:39], v245 offset:4096
    ds_read_b64_tr_b16 v[40:41], v246 offset:0
    ds_read_b64_tr_b16 v[42:43], v246 offset:4096
    ds_read_b64_tr_b16 v[44:45], v247 offset:0
    ds_read_b64_tr_b16 v[46:47], v247 offset:4096
    s_cmp_eq_u32 s21, 0
    s_cbranch_scc1 L2_np
    s_setprio 1
L2_np:
    s_waitcnt vmcnt(3)
    s_waitcnt lgkmcnt(14)
    v_mfma_f32_16x16x32_bf16 v[112:115], v[16:19], v[176:179], 0
    ds_read_b128 v[88:91], v3 offset:0
    ds_read_b128 v[92:95], v3 offset:1024
    s_waitcnt vmcnt(2)
    v_mfma_f32_16x16x32_bf16 v[144:147], v[16:19], v[180:183], 0
    ds_read_b64_tr_b16 v[48:49], v240 offset:8192
    ds_read_b64_tr_b16 v[50:51], v240 offset:12288
    s_add_u32 m0, s91, 49152
    s_add_u32 s62, s86, 458752
    buffer_load_dwordx4 v13, s[36:39], s62 offen lds
    ds_read_b64_tr_b16 v[96:97], v4 offset:0
    ds_read_b64_tr_b16 v[98:99], v4 offset:1024
    s_waitcnt lgkmcnt(15)
    v_mfma_f32_16x16x32_bf16 v[148:151], v[20:23], v[180:183], 0
    ds_read_b64_tr_b16 v[100:101], v4 offset:32
    ds_read_b64_tr_b16 v[102:103], v4 offset:1056
    v_mfma_f32_16x16x32_bf16 v[116:119], v[20:23], v[176:179], 0
    ds_read_b64_tr_b16 v[52:53], v241 offset:8192
    ds_read_b64_tr_b16 v[54:55], v241 offset:12288
    s_add_u32 s63, s89, 16384
    buffer_load_dwordx4 v[192:195], v2, s[44:47], s63 offen sc1
    v_mfma_f32_16x16x32_bf16 v[120:123], v[24:27], v[176:179], 0
    v_mfma_f32_16x16x32_bf16 v[152:155], v[24:27], v[180:183], 0
    ds_read_b64_tr_b16 v[16:17], v242 offset:8192
    ds_read_b64_tr_b16 v[18:19], v242 offset:12288
    s_waitcnt lgkmcnt(15)
    v_mfma_f32_16x16x32_bf16 v[156:159], v[28:31], v[180:183], 0
    buffer_load_dwordx4 v[196:199], v2, s[44:47], s63 offen offset:1024 sc1
    s_waitcnt lgkmcnt(6)
    v_mfma_f32_16x16x32_bf16 v[56:59], v[96:99], v[88:91], 0
    s_waitcnt lgkmcnt(4)
    v_mfma_f32_16x16x32_bf16 v[60:63], v[100:103], v[88:91], 0
    v_mfma_f32_16x16x32_bf16 v[124:127], v[28:31], v[176:179], 0
    ds_read_b64_tr_b16 v[20:21], v243 offset:8192
    ds_read_b64_tr_b16 v[22:23], v243 offset:12288
    v_mfma_f32_16x16x32_bf16 v[64:67], v[96:99], v[92:95], 0
    v_mfma_f32_16x16x32_bf16 v[68:71], v[100:103], v[92:95], 0
    v_mfma_f32_16x16x32_bf16 v[128:131], v[32:35], v[176:179], 0
    s_add_u32 s63, s89, 24576
    buffer_load_dwordx4 v[200:203], v2, s[44:47], s63 offen sc1
    v_mfma_f32_16x16x32_bf16 v[160:163], v[32:35], v[180:183], 0
    ds_read_b64_tr_b16 v[24:25], v244 offset:8192
    ds_read_b64_tr_b16 v[26:27], v244 offset:12288
    v_mfma_f32_16x16x32_bf16 v[164:167], v[36:39], v[180:183], 0
    v_max3_f32 v88, v56, v57, v58
    v_max3_f32 v90, v64, v65, v66
    v_mfma_f32_16x16x32_bf16 v[132:135], v[36:39], v[176:179], 0
    ds_read_b64_tr_b16 v[28:29], v245 offset:8192
    ds_read_b64_tr_b16 v[30:31], v245 offset:12288
    buffer_load_dwordx4 v[204:207], v2, s[44:47], s63 offen offset:1024 sc1
    v_max3_f32 v92, -v56, -v57, -v58
    v_max3_f32 v94, -v64, -v65, -v66
    v_mfma_f32_16x16x32_bf16 v[136:139], v[40:43], v[176:179], 0
    v_max3_f32 v88, v88, v59, v60
    v_max3_f32 v90, v90, v67, v68
    v_mfma_f32_16x16x32_bf16 v[168:171], v[40:43], v[180:183], 0
    ds_read_b64_tr_b16 v[32:33], v246 offset:8192
    ds_read_b64_tr_b16 v[34:35], v246 offset:12288
    v_max3_f32 v92, v92, -v59, -v60
    v_max3_f32 v94, v94, -v67, -v68
    v_mfma_f32_16x16x32_bf16 v[172:175], v[44:47], v[180:183], 0
    v_max3_f32 v88, v88, v61, v62
    v_max3_f32 v90, v90, v69, v70
    v_mfma_f32_16x16x32_bf16 v[140:143], v[44:47], v[176:179], 0
    ds_read_b64_tr_b16 v[36:37], v247 offset:8192
    ds_read_b64_tr_b16 v[38:39], v247 offset:12288
    v_max3_f32 v92, v92, -v61, -v62
    v_max3_f32 v94, v94, -v69, -v70
    s_waitcnt vmcnt(6)
    v_mfma_f32_16x16x32_bf16 v[112:115], v[48:51], v[184:187], v[112:115]
    v_max_f32 v88, v88, v63
    v_max_f32 v90, v90, v71
    s_waitcnt vmcnt(5)
    v_mfma_f32_16x16x32_bf16 v[144:147], v[48:51], v[188:191], v[144:147]
    ds_read_b64_tr_b16 v[40:41], v240 offset:16384
    ds_read_b64_tr_b16 v[42:43], v240 offset:20480
    s_add_u32 m0, s91, 57344
    s_add_u32 s62, s86, 524288
    buffer_load_dwordx4 v13, s[36:39], s62 offen lds
    v_max_f32 v92, v92, -v63
    v_max_f32 v94, v94, -v71
    s_waitcnt lgkmcnt(14)
    v_mfma_f32_16x16x32_bf16 v[148:151], v[52:55], v[188:191], v[148:151]
    v_permlane16_swap_b32 v88, v90
    v_permlane16_swap_b32 v92, v94
    v_mfma_f32_16x16x32_bf16 v[116:119], v[52:55], v[184:187], v[116:119]
    ds_read_b64_tr_b16 v[44:45], v241 offset:16384
    ds_read_b64_tr_b16 v[46:47], v241 offset:20480
    s_add_u32 s63, s89, 32768
    buffer_load_dwordx4 v[208:211], v2, s[44:47], s63 offen sc1
    v_max_f32 v88, v88, v90
    v_max_f32 v92, v92, v94
    s_waitcnt lgkmcnt(14)
    v_mfma_f32_16x16x32_bf16 v[120:123], v[16:19], v[184:187], v[120:123]
    v_permlane32_swap_b32 v88, v92
    v_max_f32 v88, v88, v92
    v_mfma_f32_16x16x32_bf16 v[152:155], v[16:19], v[188:191], v[152:155]
    ds_read_b64_tr_b16 v[48:49], v242 offset:16384
    ds_read_b64_tr_b16 v[50:51], v242 offset:20480
    v_mul_f32 v88, s58, v88
    v_mov_b32 v92, v88
    s_waitcnt lgkmcnt(14)
    v_mfma_f32_16x16x32_bf16 v[156:159], v[20:23], v[188:191], v[156:159]
    buffer_load_dwordx4 v[212:215], v2, s[44:47], s63 offen offset:1024 sc1
    v_permlane32_swap_b32 v88, v92
    v_mov_b32 v94, v92
    v_mfma_f32_16x16x32_bf16 v[124:127], v[20:23], v[184:187], v[124:127]
    ds_read_b64_tr_b16 v[52:53], v243 offset:16384
    ds_read_b64_tr_b16 v[54:55], v243 offset:20480
    v_mov_b32 v90, v88
    v_permlane16_swap_b32 v92, v94
    s_waitcnt lgkmcnt(14)
    v_mfma_f32_16x16x32_bf16 v[128:131], v[24:27], v[184:187], v[128:131]
    s_add_u32 s63, s89, 40960
    buffer_load_dwordx4 v[216:219], v2, s[44:47], s63 offen sc1
    v_permlane16_swap_b32 v88, v90
    v_mov_b32 v93, v92
    v_mfma_f32_16x16x32_bf16 v[160:163], v[24:27], v[188:191], v[160:163]
    ds_read_b64_tr_b16 v[16:17], v244 offset:16384
    ds_read_b64_tr_b16 v[18:19], v244 offset:20480
    v_mov_b32 v95, v94
    v_mov_b32 v89, v88
    s_waitcnt lgkmcnt(14)
    v_mfma_f32_16x16x32_bf16 v[164:167], v[28:31], v[188:191], v[164:167]
    v_mov_b32 v91, v90
    v_fma_f32 v72, v56, s52, -v92
    v_mfma_f32_16x16x32_bf16 v[132:135], v[28:31], v[184:187], v[132:135]
    ds_read_b64_tr_b16 v[20:21], v245 offset:16384
    ds_read_b64_tr_b16 v[22:23], v245 offset:20480
    buffer_load_dwordx4 v[220:223], v2, s[44:47], s63 offen offset:1024 sc1
    v_fma_f32 v73, v57, s53, -v93
    v_exp_f32 v72, v72
    s_waitcnt lgkmcnt(14)
    v_mfma_f32_16x16x32_bf16 v[136:139], v[32:35], v[184:187], v[136:139]
    v_fma_f32 v74, v58, s52, -v92
    v_exp_f32 v73, v73
    v_mfma_f32_16x16x32_bf16 v[168:171], v[32:35], v[188:191], v[168:171]
    ds_read_b64_tr_b16 v[24:25], v246 offset:16384
    ds_read_b64_tr_b16 v[26:27], v246 offset:20480
    v_fma_f32 v75, v59, s53, -v93
    v_exp_f32 v74, v74
    s_waitcnt lgkmcnt(14)
    v_mfma_f32_16x16x32_bf16 v[172:175], v[36:39], v[188:191], v[172:175]
    v_fma_f32 v80, v64, s52, -v94
    v_exp_f32 v75, v75
    v_mfma_f32_16x16x32_bf16 v[140:143], v[36:39], v[184:187], v[140:143]
    ds_read_b64_tr_b16 v[28:29], v247 offset:16384
    ds_read_b64_tr_b16 v[30:31], v247 offset:20480
    v_fma_f32 v81, v65, s53, -v95
    v_exp_f32 v80, v80
    s_barrier
    s_waitcnt vmcnt(8)
    s_waitcnt lgkmcnt(14)
    v_mfma_f32_16x16x32_bf16 v[112:115], v[40:43], v[192:195], v[112:115]
    v_fma_f32 v82, v66, s52, -v94
    v_exp_f32 v81, v81
    s_waitcnt vmcnt(7)
    v_mfma_f32_16x16x32_bf16 v[144:147], v[40:43], v[196:199], v[144:147]
    ds_read_b64_tr_b16 v[32:33], v240 offset:24576
    ds_read_b64_tr_b16 v[34:35], v240 offset:28672
    s_add_u32 m0, s91, 0
    s_add_u32 s62, s86, 589824
    buffer_load_dwordx4 v13, s[36:39], s62 offen lds
    v_fma_f32 v83, v67, s53, -v95
    v_exp_f32 v82, v82
    s_waitcnt lgkmcnt(14)
    v_mfma_f32_16x16x32_bf16 v[148:151], v[44:47], v[196:199], v[148:151]
    v_fma_f32 v56, v56, s58, -v88
    v_exp_f32 v83, v83
    v_mfma_f32_16x16x32_bf16 v[116:119], v[44:47], v[192:195], v[116:119]
    ds_read_b64_tr_b16 v[36:37], v241 offset:24576
    ds_read_b64_tr_b16 v[38:39], v241 offset:28672
    s_add_u32 s63, s89, 49152
    buffer_load_dwordx4 v[224:227], v2, s[44:47], s63 offen sc1
    v_fma_f32 v57, v57, s59, -v89
    v_exp_f32 v56, v56
    s_waitcnt lgkmcnt(14)
    v_mfma_f32_16x16x32_bf16 v[120:123], v[48:51], v[192:195], v[120:123]
    v_fma_f32 v58, v58, s58, -v88
    v_exp_f32 v57, v57
    v_mfma_f32_16x16x32_bf16 v[152:155], v[48:51], v[196:199], v[152:155]
    ds_read_b64_tr_b16 v[40:41], v242 offset:24576
    ds_read_b64_tr_b16 v[42:43], v242 offset:28672
    v_fma_f32 v59, v59, s59, -v89
    v_exp_f32 v58, v58
    s_waitcnt lgkmcnt(14)
    v_mfma_f32_16x16x32_bf16 v[156:159], v[52:55], v[196:199], v[156:159]
    buffer_load_dwordx4 v[228:231], v2, s[44:47], s63 offen offset:1024 sc1
    v_fma_f32 v64, v64, s58, -v90
    v_exp_f32 v59, v59
    v_mfma_f32_16x16x32_bf16 v[124:127], v[52:55], v[192:195], v[124:127]
    ds_read_b64_tr_b16 v[44:45], v243 offset:24576
    ds_read_b64_tr_b16 v[46:47], v243 offset:28672
    v_fma_f32 v65, v65, s59, -v91
    v_exp_f32 v64, v64
    s_waitcnt lgkmcnt(14)
    v_mfma_f32_16x16x32_bf16 v[128:131], v[16:19], v[192:195], v[128:131]
    s_add_u32 s63, s89, 57344
    buffer_load_dwordx4 v[232:235], v2, s[44:47], s63 offen sc1
    v_fma_f32 v66, v66, s58, -v90
    v_exp_f32 v65, v65
    v_mfma_f32_16x16x32_bf16 v[160:163], v[16:19], v[196:199], v[160:163]
    ds_read_b64_tr_b16 v[48:49], v244 offset:24576
    ds_read_b64_tr_b16 v[50:51], v244 offset:28672
    v_fma_f32 v67, v67, s59, -v91
    v_exp_f32 v66, v66
    s_waitcnt lgkmcnt(14)
    v_mfma_f32_16x16x32_bf16 v[164:167], v[20:23], v[196:199], v[164:167]
    v_fma_f32 v76, v60, s52, -v92
    v_exp_f32 v67, v67
    v_mfma_f32_16x16x32_bf16 v[132:135], v[20:23], v[192:195], v[132:135]
    ds_read_b64_tr_b16 v[52:53], v245 offset:24576
    ds_read_b64_tr_b16 v[54:55], v245 offset:28672
    buffer_load_dwordx4 v[236:239], v2, s[44:47], s63 offen offset:1024 sc1
    v_fma_f32 v77, v61, s53, -v93
    v_exp_f32 v76, v76
    s_waitcnt lgkmcnt(14)
    v_mfma_f32_16x16x32_bf16 v[136:139], v[24:27], v[192:195], v[136:139]
    v_fma_f32 v84, v68, s52, -v94
    v_exp_f32 v77, v77
    v_mfma_f32_16x16x32_bf16 v[168:171], v[24:27], v[196:199], v[168:171]
    ds_read_b64_tr_b16 v[16:17], v246 offset:24576
    ds_read_b64_tr_b16 v[18:19], v246 offset:28672
    v_fma_f32 v85, v69, s53, -v95
    v_exp_f32 v84, v84
    s_waitcnt lgkmcnt(14)
    v_mfma_f32_16x16x32_bf16 v[172:175], v[28:31], v[196:199], v[172:175]
    v_fma_f32 v60, v60, s58, -v88
    v_exp_f32 v85, v85
    v_mfma_f32_16x16x32_bf16 v[140:143], v[28:31], v[192:195], v[140:143]
    ds_read_b64_tr_b16 v[20:21], v247 offset:24576
    ds_read_b64_tr_b16 v[22:23], v247 offset:28672
    v_fma_f32 v61, v61, s59, -v89
    v_exp_f32 v60, v60
    s_waitcnt vmcnt(11)
    s_waitcnt lgkmcnt(14)
    v_mfma_f32_16x16x32_bf16 v[112:115], v[32:35], v[200:203], v[112:115]
    v_fma_f32 v68, v68, s58, -v90
    v_exp_f32 v61, v61
    s_waitcnt vmcnt(10)
    v_mfma_f32_16x16x32_bf16 v[144:147], v[32:35], v[204:207], v[144:147]
    ds_read_b64_tr_b16 v[24:25], v240 offset:32768
    ds_read_b64_tr_b16 v[26:27], v240 offset:36864
    s_add_u32 m0, s91, 8192
    s_add_u32 s62, s86, 688128
    buffer_load_dwordx4 v13, s[36:39], s62 offen lds
    v_fma_f32 v69, v69, s59, -v91
    v_exp_f32 v68, v68
    s_waitcnt lgkmcnt(14)
    v_mfma_f32_16x16x32_bf16 v[148:151], v[36:39], v[204:207], v[148:151]
    v_fma_f32 v78, v62, s52, -v92
    v_exp_f32 v69, v69
    v_mfma_f32_16x16x32_bf16 v[116:119], v[36:39], v[200:203], v[116:119]
    ds_read_b64_tr_b16 v[28:29], v241 offset:32768
    ds_read_b64_tr_b16 v[30:31], v241 offset:36864
    s_add_u32 s63, s89, 65536
    buffer_load_dwordx4 v[176:179], v2, s[44:47], s63 offen sc1
    v_fma_f32 v79, v63, s53, -v93
    v_exp_f32 v78, v78
    s_waitcnt lgkmcnt(14)
    v_mfma_f32_16x16x32_bf16 v[120:123], v[40:43], v[200:203], v[120:123]
    v_fma_f32 v86, v70, s52, -v94
    v_exp_f32 v79, v79
    v_mfma_f32_16x16x32_bf16 v[152:155], v[40:43], v[204:207], v[152:155]
    ds_read_b64_tr_b16 v[32:33], v242 offset:32768
    ds_read_b64_tr_b16 v[34:35], v242 offset:36864
    v_fma_f32 v87, v71, s53, -v95
    v_exp_f32 v86, v86
    s_waitcnt lgkmcnt(14)
    v_mfma_f32_16x16x32_bf16 v[156:159], v[44:47], v[204:207], v[156:159]
    buffer_load_dwordx4 v[180:183], v2, s[44:47], s63 offen offset:1024 sc1
    v_fma_f32 v62, v62, s58, -v88
    v_exp_f32 v87, v87
    v_mfma_f32_16x16x32_bf16 v[124:127], v[44:47], v[200:203], v[124:127]
    ds_read_b64_tr_b16 v[36:37], v243 offset:32768
    ds_read_b64_tr_b16 v[38:39], v243 offset:36864
    v_fma_f32 v63, v63, s59, -v89
    v_exp_f32 v62, v62
    s_waitcnt lgkmcnt(14)
    v_mfma_f32_16x16x32_bf16 v[128:131], v[48:51], v[200:203], v[128:131]
    s_add_u32 s63, s89, 73728
    buffer_load_dwordx4 v[184:187], v2, s[44:47], s63 offen sc1
    v_fma_f32 v70, v70, s58, -v90
    v_exp_f32 v63, v63
    v_mfma_f32_16x16x32_bf16 v[160:163], v[48:51], v[204:207], v[160:163]
    ds_read_b64_tr_b16 v[40:41], v244 offset:32768
    ds_read_b64_tr_b16 v[42:43], v244 offset:36864
    v_fma_f32 v71, v71, s59, -v91
    v_exp_f32 v70, v70
    s_waitcnt lgkmcnt(14)
    v_mfma_f32_16x16x32_bf16 v[164:167], v[52:55], v[204:207], v[164:167]
    v_add_f32 v88, v56, v58
    v_exp_f32 v71, v71
    v_mfma_f32_16x16x32_bf16 v[132:135], v[52:55], v[200:203], v[132:135]
    ds_read_b64_tr_b16 v[44:45], v245 offset:32768
    ds_read_b64_tr_b16 v[46:47], v245 offset:36864
    buffer_load_dwordx4 v[188:191], v2, s[44:47], s63 offen offset:1024 sc1
    v_add_f32 v89, v57, v59
    v_add_f32 v90, v64, v66
    s_waitcnt lgkmcnt(14)
    v_mfma_f32_16x16x32_bf16 v[136:139], v[16:19], v[200:203], v[136:139]
    v_add_f32 v91, v65, v67
    v_add_f32 v92, v72, v74
    v_mfma_f32_16x16x32_bf16 v[168:171], v[16:19], v[204:207], v[168:171]
    ds_read_b64_tr_b16 v[48:49], v246 offset:32768
    ds_read_b64_tr_b16 v[50:51], v246 offset:36864
    v_add_f32 v93, v73, v75
    v_add_f32 v94, v80, v82
    s_waitcnt lgkmcnt(14)
    v_mfma_f32_16x16x32_bf16 v[172:175], v[20:23], v[204:207], v[172:175]
    v_add_f32 v95, v81, v83
    v_add_f32 v88, v88, v60
    v_mfma_f32_16x16x32_bf16 v[140:143], v[20:23], v[200:203], v[140:143]
    ds_read_b64_tr_b16 v[52:53], v247 offset:32768
    ds_read_b64_tr_b16 v[54:55], v247 offset:36864
    v_add_f32 v89, v89, v61
    v_add_f32 v90, v90, v68
    s_barrier
    s_cmp_eq_u32 s20, 4
    s_cbranch_scc0 L2_f3
    v_mov_b32 v254, 3
    s_mov_b64 exec, 1
    buffer_store_dword v254, off, s[44:47], s3 sc1
    s_mov_b64 exec, -1
L2_f3:
    s_waitcnt vmcnt(13)
    s_waitcnt lgkmcnt(14)
    v_mfma_f32_16x16x32_bf16 v[112:115], v[24:27], v[208:211], v[112:115]
    v_add_f32 v91, v91, v69
    v_add_f32 v92, v92, v76
    s_waitcnt vmcnt(12)
    v_mfma_f32_16x16x32_bf16 v[144:147], v[24:27], v[212:215], v[144:147]
    ds_read_b64_tr_b16 v[16:17], v240 offset:40960
    ds_read_b64_tr_b16 v[18:19], v240 offset:45056
    s_add_u32 m0, s91, 16384
    s_add_u32 s62, s86, 753664
    buffer_load_dwordx4 v13, s[36:39], s62 offen lds
    v_add_f32 v93, v93, v77
    v_add_f32 v94, v94, v84
    s_waitcnt lgkmcnt(14)
    v_mfma_f32_16x16x32_bf16 v[148:151], v[28:31], v[212:215], v[148:151]
    v_add_f32 v95, v95, v85
    v_add_f32 v88, v88, v62
    v_mfma_f32_16x16x32_bf16 v[116:119], v[28:31], v[208:211], v[116:119]
    ds_read_b64_tr_b16 v[20:21], v241 offset:40960
    ds_read_b64_tr_b16 v[22:23], v241 offset:45056
    v_add_f32 v89, v89, v63
    v_add_f32 v90, v90, v70
    s_waitcnt lgkmcnt(14)
    v_mfma_f32_16x16x32_bf16 v[120:123], v[32:35], v[208:211], v[120:123]
    v_add_f32 v91, v91, v71
    v_add_f32 v92, v92, v78
    v_mfma_f32_16x16x32_bf16 v[152:155], v[32:35], v[212:215], v[152:155]
    ds_read_b64_tr_b16 v[24:25], v242 offset:40960
    ds_read_b64_tr_b16 v[26:27], v242 offset:45056
    s_add_u32 s63, s89, 81920
    buffer_load_dwordx4 v[192:195], v2, s[44:47], s63 offen sc1
    v_add_f32 v93, v93, v79
    v_add_f32 v94, v94, v86
    s_waitcnt lgkmcnt(14)
    v_mfma_f32_16x16x32_bf16 v[156:159], v[36:39], v[212:215], v[156:159]
    v_add_f32 v95, v95, v87
    v_add_f32 v88, v88, v89
    v_mfma_f32_16x16x32_bf16 v[124:127], v[36:39], v[208:211], v[124:127]
    ds_read_b64_tr_b16 v[28:29], v243 offset:40960
    ds_read_b64_tr_b16 v[30:31], v243 offset:45056
    v_add_f32 v90, v90, v91
    v_add_f32 v92, v92, v93
    s_waitcnt lgkmcnt(14)
    v_mfma_f32_16x16x32_bf16 v[128:131], v[40:43], v[208:211], v[128:131]
    v_add_f32 v94, v94, v95
    v_permlane16_swap_b32 v88, v90
    v_mfma_f32_16x16x32_bf16 v[160:163], v[40:43], v[212:215], v[160:163]
    ds_read_b64_tr_b16 v[32:33], v244 offset:40960
    ds_read_b64_tr_b16 v[34:35], v244 offset:45056
    buffer_load_dwordx4 v[196:199], v2, s[44:47], s63 offen offset:1024 sc1
    v_permlane16_swap_b32 v92, v94
    v_add_f32 v88, v88, v90
    s_waitcnt lgkmcnt(14)
    v_mfma_f32_16x16x32_bf16 v[164:167], v[44:47], v[212:215], v[164:167]
    v_add_f32 v92, v92, v94
    s_nop 1
    v_permlane32_swap_b32 v88, v92
    v_mfma_f32_16x16x32_bf16 v[132:135], v[44:47], v[208:211], v[132:135]
    ds_read_b64_tr_b16 v[36:37], v245 offset:40960
    ds_read_b64_tr_b16 v[38:39], v245 offset:45056
    v_add_f32 v88, v88, v92
    v_rcp_f32 v88, v88
    s_waitcnt lgkmcnt(14)
    v_mfma_f32_16x16x32_bf16 v[136:139], v[48:51], v[208:211], v[136:139]
    v_mov_b32 v92, v88
    s_nop 1
    v_permlane32_swap_b32 v88, v92
    v_mfma_f32_16x16x32_bf16 v[168:171], v[48:51], v[212:215], v[168:171]
    ds_read_b64_tr_b16 v[40:41], v246 offset:40960
    ds_read_b64_tr_b16 v[42:43], v246 offset:45056
    v_mov_b32 v90, v88
    v_mov_b32 v94, v92
    s_waitcnt lgkmcnt(14)
    v_mfma_f32_16x16x32_bf16 v[172:175], v[52:55], v[212:215], v[172:175]
    v_permlane16_swap_b32 v88, v90
    v_permlane16_swap_b32 v92, v94
    v_mfma_f32_16x16x32_bf16 v[140:143], v[52:55], v[208:211], v[140:143]
    ds_read_b64_tr_b16 v[44:45], v247 offset:40960
    ds_read_b64_tr_b16 v[46:47], v247 offset:45056
    v_mov_b32 v89, v88
    v_mov_b32 v91, v90
    s_waitcnt vmcnt(14)
    s_waitcnt lgkmcnt(14)
    v_mfma_f32_16x16x32_bf16 v[112:115], v[16:19], v[216:219], v[112:115]
    v_mov_b32 v93, v92
    v_mov_b32 v95, v94
    s_waitcnt vmcnt(13)
    v_mfma_f32_16x16x32_bf16 v[144:147], v[16:19], v[220:223], v[144:147]
    ds_read_b64_tr_b16 v[48:49], v240 offset:49152
    ds_read_b64_tr_b16 v[50:51], v240 offset:53248
    s_add_u32 m0, s91, 24576
    s_add_u32 s62, s86, 819200
    buffer_load_dwordx4 v13, s[36:39], s62 offen lds
    v_mul_f32 v56, v56, v88
    v_mul_f32 v57, v57, v89
    s_waitcnt lgkmcnt(14)
    v_mfma_f32_16x16x32_bf16 v[148:151], v[20:23], v[220:223], v[148:151]
    v_mul_f32 v58, v58, v88
    v_mul_f32 v59, v59, v89
    v_mfma_f32_16x16x32_bf16 v[116:119], v[20:23], v[216:219], v[116:119]
    ds_read_b64_tr_b16 v[52:53], v241 offset:49152
    ds_read_b64_tr_b16 v[54:55], v241 offset:53248
    v_mul_f32 v60, v60, v88
    v_mul_f32 v61, v61, v89
    s_waitcnt lgkmcnt(14)
    v_mfma_f32_16x16x32_bf16 v[120:123], v[24:27], v[216:219], v[120:123]
    v_mul_f32 v62, v62, v88
    v_mul_f32 v63, v63, v89
    v_mfma_f32_16x16x32_bf16 v[152:155], v[24:27], v[220:223], v[152:155]
    ds_read_b64_tr_b16 v[16:17], v242 offset:49152
    ds_read_b64_tr_b16 v[18:19], v242 offset:53248
    s_add_u32 s63, s89, 90112
    buffer_load_dwordx4 v[200:203], v2, s[44:47], s63 offen sc1
    v_mul_f32 v64, v64, v90
    v_mul_f32 v65, v65, v91
    s_waitcnt lgkmcnt(14)
    v_mfma_f32_16x16x32_bf16 v[156:159], v[28:31], v[220:223], v[156:159]
    v_mul_f32 v66, v66, v90
    v_mul_f32 v67, v67, v91
    v_mfma_f32_16x16x32_bf16 v[124:127], v[28:31], v[216:219], v[124:127]
    ds_read_b64_tr_b16 v[20:21], v243 offset:49152
    ds_read_b64_tr_b16 v[22:23], v243 offset:53248
    v_mul_f32 v68, v68, v90
    v_mul_f32 v69, v69, v91
    s_waitcnt lgkmcnt(14)
    v_mfma_f32_16x16x32_bf16 v[128:131], v[32:35], v[216:219], v[128:131]
    v_mul_f32 v70, v70, v90
    v_mul_f32 v71, v71, v91
    v_mfma_f32_16x16x32_bf16 v[160:163], v[32:35], v[220:223], v[160:163]
    ds_read_b64_tr_b16 v[24:25], v244 offset:49152
    ds_read_b64_tr_b16 v[26:27], v244 offset:53248
    buffer_load_dwordx4 v[204:207], v2, s[44:47], s63 offen offset:1024 sc1
    v_mul_f32 v72, v72, v92
    v_mul_f32 v73, v73, v93
    s_waitcnt lgkmcnt(14)
    v_mfma_f32_16x16x32_bf16 v[164:167], v[36:39], v[220:223], v[164:167]
    v_mul_f32 v74, v74, v92
    v_mul_f32 v75, v75, v93
    v_mfma_f32_16x16x32_bf16 v[132:135], v[36:39], v[216:219], v[132:135]
    ds_read_b64_tr_b16 v[28:29], v245 offset:49152
    ds_read_b64_tr_b16 v[30:31], v245 offset:53248
    v_mul_f32 v76, v76, v92
    v_mul_f32 v77, v77, v93
    s_waitcnt lgkmcnt(14)
    v_mfma_f32_16x16x32_bf16 v[136:139], v[40:43], v[216:219], v[136:139]
    v_mul_f32 v78, v78, v92
    v_mul_f32 v79, v79, v93
    v_mfma_f32_16x16x32_bf16 v[168:171], v[40:43], v[220:223], v[168:171]
    ds_read_b64_tr_b16 v[32:33], v246 offset:49152
    ds_read_b64_tr_b16 v[34:35], v246 offset:53248
    v_mul_f32 v80, v80, v94
    v_mul_f32 v81, v81, v95
    s_waitcnt lgkmcnt(14)
    v_mfma_f32_16x16x32_bf16 v[172:175], v[44:47], v[220:223], v[172:175]
    v_mul_f32 v82, v82, v94
    v_mul_f32 v83, v83, v95
    v_mfma_f32_16x16x32_bf16 v[140:143], v[44:47], v[216:219], v[140:143]
    ds_read_b64_tr_b16 v[36:37], v247 offset:49152
    ds_read_b64_tr_b16 v[38:39], v247 offset:53248
    v_mul_f32 v84, v84, v94
    v_mul_f32 v85, v85, v95
    s_waitcnt vmcnt(15)
    s_barrier
    v_and_b32 v252, 7, v1
    s_andn2_b32 s68, s3, 0x7000
    v_lshl_add_u32 v252, v252, 12, s68
    s_waitcnt vmcnt(14)
    s_waitcnt lgkmcnt(14)
    v_mfma_f32_16x16x32_bf16 v[112:115], v[48:51], v[224:227], v[112:115]
    v_mul_f32 v86, v86, v94
    v_mul_f32 v87, v87, v95
    s_waitcnt vmcnt(13)
    v_mfma_f32_16x16x32_bf16 v[144:147], v[48:51], v[228:231], v[144:147]
    ds_read_b64_tr_b16 v[40:41], v240 offset:57344
    ds_read_b64_tr_b16 v[42:43], v240 offset:61440
    s_add_u32 m0, s91, 32768
    s_add_u32 s62, s86, 917504
    buffer_load_dwordx4 v13, s[36:39], s62 offen lds
    v_cvt_pk_bf16_f32 v96, v56, v57
    v_cvt_pk_bf16_f32 v97, v58, v59
    s_waitcnt lgkmcnt(14)
    v_mfma_f32_16x16x32_bf16 v[148:151], v[52:55], v[228:231], v[148:151]
    v_cvt_pk_bf16_f32 v98, v60, v61
    v_cvt_pk_bf16_f32 v99, v62, v63
    v_mfma_f32_16x16x32_bf16 v[116:119], v[52:55], v[224:227], v[116:119]
    ds_read_b64_tr_b16 v[44:45], v241 offset:57344
    ds_read_b64_tr_b16 v[46:47], v241 offset:61440
    v_cvt_pk_bf16_f32 v104, v64, v65
    v_cvt_pk_bf16_f32 v105, v66, v67
    s_waitcnt lgkmcnt(14)
    v_mfma_f32_16x16x32_bf16 v[120:123], v[16:19], v[224:227], v[120:123]
    v_cvt_pk_bf16_f32 v106, v68, v69
    v_cvt_pk_bf16_f32 v107, v70, v71
    v_mfma_f32_16x16x32_bf16 v[152:155], v[16:19], v[228:231], v[152:155]
    ds_read_b64_tr_b16 v[48:49], v242 offset:57344
    ds_read_b64_tr_b16 v[50:51], v242 offset:61440
    s_add_u32 s63, s89, 98304
    buffer_load_dwordx4 v[208:211], v2, s[44:47], s63 offen sc1
    v_cvt_pk_bf16_f32 v100, v72, v73
    v_cvt_pk_bf16_f32 v101, v74, v75
    s_waitcnt lgkmcnt(14)
    v_mfma_f32_16x16x32_bf16 v[156:159], v[20:23], v[228:231], v[156:159]
    v_cvt_pk_bf16_f32 v102, v76, v77
    v_cvt_pk_bf16_f32 v103, v78, v79
    v_mfma_f32_16x16x32_bf16 v[124:127], v[20:23], v[224:227], v[124:127]
    ds_read_b64_tr_b16 v[52:53], v243 offset:57344
    ds_read_b64_tr_b16 v[54:55], v243 offset:61440
    v_cvt_pk_bf16_f32 v108, v80, v81
    v_cvt_pk_bf16_f32 v109, v82, v83
    s_waitcnt lgkmcnt(14)
    v_mfma_f32_16x16x32_bf16 v[128:131], v[24:27], v[224:227], v[128:131]
    v_cvt_pk_bf16_f32 v110, v84, v85
    v_cvt_pk_bf16_f32 v111, v86, v87
    v_mfma_f32_16x16x32_bf16 v[160:163], v[24:27], v[228:231], v[160:163]
    ds_read_b64_tr_b16 v[16:17], v244 offset:57344
    ds_read_b64_tr_b16 v[18:19], v244 offset:61440
    buffer_load_dwordx4 v[212:215], v2, s[44:47], s63 offen offset:1024 sc1
    s_waitcnt lgkmcnt(14)
    v_mfma_f32_16x16x32_bf16 v[164:167], v[28:31], v[228:231], v[164:167]
    v_mfma_f32_16x16x32_bf16 v[132:135], v[28:31], v[224:227], v[132:135]
    ds_read_b64_tr_b16 v[20:21], v245 offset:57344
    ds_read_b64_tr_b16 v[22:23], v245 offset:61440
    s_waitcnt lgkmcnt(14)
    v_mfma_f32_16x16x32_bf16 v[136:139], v[32:35], v[224:227], v[136:139]
    v_mfma_f32_16x16x32_bf16 v[168:171], v[32:35], v[228:231], v[168:171]
    ds_read_b64_tr_b16 v[24:25], v246 offset:57344
    ds_read_b64_tr_b16 v[26:27], v246 offset:61440
    s_waitcnt lgkmcnt(14)
    v_mfma_f32_16x16x32_bf16 v[172:175], v[36:39], v[228:231], v[172:175]
    v_mfma_f32_16x16x32_bf16 v[140:143], v[36:39], v[224:227], v[140:143]
    ds_read_b64_tr_b16 v[28:29], v247 offset:57344
    ds_read_b64_tr_b16 v[30:31], v247 offset:61440
    s_cmp_eq_u32 s20, 5
    s_cbranch_scc0 L2_q7
    buffer_load_dword v254, v252, s[44:47], 0 offen sc1
L2_q7:
    s_waitcnt vmcnt(15)
    s_waitcnt lgkmcnt(14)
    v_mfma_f32_16x16x32_bf16 v[112:115], v[40:43], v[232:235], v[112:115]
    s_waitcnt vmcnt(14)
    v_mfma_f32_16x16x32_bf16 v[144:147], v[40:43], v[236:239], v[144:147]
    ds_read_b64_tr_b16 v[32:33], v240 offset:0
    ds_read_b64_tr_b16 v[34:35], v240 offset:4096
    s_add_u32 m0, s91, 40960
    s_add_u32 s62, s86, 983040
    buffer_load_dwordx4 v13, s[36:39], s62 offen lds
    s_waitcnt lgkmcnt(14)
    v_mfma_f32_16x16x32_bf16 v[148:151], v[44:47], v[236:239], v[148:151]
    v_mfma_f32_16x16x32_bf16 v[116:119], v[44:47], v[232:235], v[116:119]
    ds_read_b64_tr_b16 v[36:37], v241 offset:0
    ds_read_b64_tr_b16 v[38:39], v241 offset:4096
    s_waitcnt lgkmcnt(14)
    v_mfma_f32_16x16x32_bf16 v[120:123], v[48:51], v[232:235], v[120:123]
    v_mfma_f32_16x16x32_bf16 v[152:155], v[48:51], v[236:239], v[152:155]
    ds_read_b64_tr_b16 v[40:41], v242 offset:0
    ds_read_b64_tr_b16 v[42:43], v242 offset:4096
    s_add_u32 s63, s89, 106496
    buffer_load_dwordx4 v[216:219], v2, s[44:47], s63 offen sc1
    s_waitcnt lgkmcnt(14)
    v_mfma_f32_16x16x32_bf16 v[156:159], v[52:55], v[236:239], v[156:159]
    v_mfma_f32_16x16x32_bf16 v[124:127], v[52:55], v[232:235], v[124:127]
    ds_read_b64_tr_b16 v[44:45], v243 offset:0
    ds_read_b64_tr_b16 v[46:47], v243 offset:4096
    s_waitcnt lgkmcnt(14)
    v_mfma_f32_16x16x32_bf16 v[128:131], v[16:19], v[232:235], v[128:131]
    v_mfma_f32_16x16x32_bf16 v[160:163], v[16:19], v[236:239], v[160:163]
    ds_read_b64_tr_b16 v[48:49], v244 offset:0
    ds_read_b64_tr_b16 v[50:51], v244 offset:4096
    buffer_load_dwordx4 v[220:223], v2, s[44:47], s63 offen offset:1024 sc1
    s_waitcnt lgkmcnt(14)
    v_mfma_f32_16x16x32_bf16 v[164:167], v[20:23], v[236:239], v[164:167]
    v_mfma_f32_16x16x32_bf16 v[132:135], v[20:23], v[232:235], v[132:135]
    ds_read_b64_tr_b16 v[52:53], v245 offset:0
    ds_read_b64_tr_b16 v[54:55], v245 offset:4096
    s_waitcnt lgkmcnt(14)
    v_mfma_f32_16x16x32_bf16 v[136:139], v[24:27], v[232:235], v[136:139]
    v_mfma_f32_16x16x32_bf16 v[168:171], v[24:27], v[236:239], v[168:171]
    ds_read_b64_tr_b16 v[16:17], v246 offset:0
    ds_read_b64_tr_b16 v[18:19], v246 offset:4096
    s_waitcnt lgkmcnt(14)
    v_mfma_f32_16x16x32_bf16 v[172:175], v[28:31], v[236:239], v[172:175]
    v_mfma_f32_16x16x32_bf16 v[140:143], v[28:31], v[232:235], v[140:143]
    ds_read_b64_tr_b16 v[20:21], v247 offset:0
    ds_read_b64_tr_b16 v[22:23], v247 offset:4096
    s_waitcnt vmcnt(11)
    s_barrier
    s_waitcnt lgkmcnt(14)
    v_mfma_f32_16x16x32_bf16 v[112:115], v[32:35], v[176:179], v[112:115]
    v_mfma_f32_16x16x32_bf16 v[144:147], v[32:35], v[180:183], v[144:147]
    ds_read_b64_tr_b16 v[24:25], v240 offset:8192
    ds_read_b64_tr_b16 v[26:27], v240 offset:12288
    s_add_u32 m0, s91, 49152
    s_add_u32 s62, s86, 1048576
    buffer_load_dwordx4 v13, s[36:39], s62 offen lds
    s_waitcnt lgkmcnt(14)
    v_mfma_f32_16x16x32_bf16 v[148:151], v[36:39], v[180:183], v[148:151]
    v_mfma_f32_16x16x32_bf16 v[116:119], v[36:39], v[176:179], v[116:119]
    ds_read_b64_tr_b16 v[28:29], v241 offset:8192
    ds_read_b64_tr_b16 v[30:31], v241 offset:12288
    s_waitcnt lgkmcnt(14)
    v_mfma_f32_16x16x32_bf16 v[120:123], v[40:43], v[176:179], v[120:123]
    v_mfma_f32_16x16x32_bf16 v[152:155], v[40:43], v[180:183], v[152:155]
    ds_read_b64_tr_b16 v[32:33], v242 offset:8192
    ds_read_b64_tr_b16 v[34:35], v242 offset:12288
    s_add_u32 s63, s89, 114688
    buffer_load_dwordx4 v[224:227], v2, s[44:47], s63 offen sc1
    s_waitcnt lgkmcnt(14)
    v_mfma_f32_16x16x32_bf16 v[156:159], v[44:47], v[180:183], v[156:159]
    v_mfma_f32_16x16x32_bf16 v[124:127], v[44:47], v[176:179], v[124:127]
    ds_read_b64_tr_b16 v[36:37], v243 offset:8192
    ds_read_b64_tr_b16 v[38:39], v243 offset:12288
    s_waitcnt lgkmcnt(14)
    v_mfma_f32_16x16x32_bf16 v[128:131], v[48:51], v[176:179], v[128:131]
    v_mfma_f32_16x16x32_bf16 v[160:163], v[48:51], v[180:183], v[160:163]
    ds_read_b64_tr_b16 v[40:41], v244 offset:8192
    ds_read_b64_tr_b16 v[42:43], v244 offset:12288
    buffer_load_dwordx4 v[228:231], v2, s[44:47], s63 offen offset:1024 sc1
    s_waitcnt lgkmcnt(14)
    v_mfma_f32_16x16x32_bf16 v[164:167], v[52:55], v[180:183], v[164:167]
    v_mfma_f32_16x16x32_bf16 v[132:135], v[52:55], v[176:179], v[132:135]
    ds_read_b64_tr_b16 v[44:45], v245 offset:8192
    ds_read_b64_tr_b16 v[46:47], v245 offset:12288
    s_waitcnt lgkmcnt(14)
    v_mfma_f32_16x16x32_bf16 v[136:139], v[16:19], v[176:179], v[136:139]
    v_mfma_f32_16x16x32_bf16 v[168:171], v[16:19], v[180:183], v[168:171]
    ds_read_b64_tr_b16 v[48:49], v246 offset:8192
    ds_read_b64_tr_b16 v[50:51], v246 offset:12288
    s_waitcnt lgkmcnt(14)
    v_mfma_f32_16x16x32_bf16 v[172:175], v[20:23], v[180:183], v[172:175]
    v_mfma_f32_16x16x32_bf16 v[140:143], v[20:23], v[176:179], v[140:143]
    ds_read_b64_tr_b16 v[52:53], v247 offset:8192
    ds_read_b64_tr_b16 v[54:55], v247 offset:12288
    s_waitcnt lgkmcnt(14)
    v_mfma_f32_16x16x32_bf16 v[112:115], v[24:27], v[184:187], v[112:115]
    v_mfma_f32_16x16x32_bf16 v[144:147], v[24:27], v[188:191], v[144:147]
    ds_read_b64_tr_b16 v[16:17], v240 offset:16384
    ds_read_b64_tr_b16 v[18:19], v240 offset:20480
    s_add_u32 m0, s91, 57344
    s_add_u32 s62, s86, 1146880
    buffer_load_dwordx4 v13, s[36:39], s62 offen lds
    s_waitcnt lgkmcnt(14)
    v_mfma_f32_16x16x32_bf16 v[148:151], v[28:31], v[188:191], v[148:151]
    v_mfma_f32_16x16x32_bf16 v[116:119], v[28:31], v[184:187], v[116:119]
    ds_read_b64_tr_b16 v[20:21], v241 offset:16384
    ds_read_b64_tr_b16 v[22:23], v241 offset:20480
    s_waitcnt lgkmcnt(14)
    v_mfma_f32_16x16x32_bf16 v[120:123], v[32:35], v[184:187], v[120:123]
    v_mfma_f32_16x16x32_bf16 v[152:155], v[32:35], v[188:191], v[152:155]
    ds_read_b64_tr_b16 v[24:25], v242 offset:16384
    ds_read_b64_tr_b16 v[26:27], v242 offset:20480
    s_add_u32 s63, s89, 122880
    buffer_load_dwordx4 v[232:235], v2, s[44:47], s63 offen sc1
    s_waitcnt lgkmcnt(14)
    v_mfma_f32_16x16x32_bf16 v[156:159], v[36:39], v[188:191], v[156:159]
    v_mfma_f32_16x16x32_bf16 v[124:127], v[36:39], v[184:187], v[124:127]
    ds_read_b64_tr_b16 v[28:29], v243 offset:16384
    ds_read_b64_tr_b16 v[30:31], v243 offset:20480
    s_waitcnt lgkmcnt(14)
    v_mfma_f32_16x16x32_bf16 v[128:131], v[40:43], v[184:187], v[128:131]
    v_mfma_f32_16x16x32_bf16 v[160:163], v[40:43], v[188:191], v[160:163]
    ds_read_b64_tr_b16 v[32:33], v244 offset:16384
    ds_read_b64_tr_b16 v[34:35], v244 offset:20480
    buffer_load_dwordx4 v[236:239], v2, s[44:47], s63 offen offset:1024 sc1
    s_waitcnt lgkmcnt(14)
    v_mfma_f32_16x16x32_bf16 v[164:167], v[44:47], v[188:191], v[164:167]
    v_mfma_f32_16x16x32_bf16 v[132:135], v[44:47], v[184:187], v[132:135]
    ds_read_b64_tr_b16 v[36:37], v245 offset:16384
    ds_read_b64_tr_b16 v[38:39], v245 offset:20480
    s_waitcnt lgkmcnt(14)
    v_mfma_f32_16x16x32_bf16 v[136:139], v[48:51], v[184:187], v[136:139]
    v_mfma_f32_16x16x32_bf16 v[168:171], v[48:51], v[188:191], v[168:171]
    ds_read_b64_tr_b16 v[40:41], v246 offset:16384
    ds_read_b64_tr_b16 v[42:43], v246 offset:20480
    s_waitcnt lgkmcnt(14)
    v_mfma_f32_16x16x32_bf16 v[172:175], v[52:55], v[188:191], v[172:175]
    v_mfma_f32_16x16x32_bf16 v[140:143], v[52:55], v[184:187], v[140:143]
    ds_read_b64_tr_b16 v[44:45], v247 offset:16384
    ds_read_b64_tr_b16 v[46:47], v247 offset:20480
    s_cmp_eq_u32 s20, 5
    s_cbranch_scc0 L2_p9_ok
    s_waitcnt vmcnt(9)
    s_mov_b32 s69, 0x40000
L2_p9:
    v_cmp_gt_u32 vcc, 3, v254
    s_cbranch_vccz L2_p9_go
    s_sub_u32 s69, s69, 1
    s_cbranch_scc1 L2_p9_go
    buffer_load_dword v254, v252, s[44:47], 0 offen sc1
    s_waitcnt vmcnt(0)
    s_branch L2_p9
L2_p9_go:
    s_cmp_lg_u32 s83, 0
    s_cbranch_scc1 L2_p9_ok
    buffer_inv sc1
    s_waitcnt vmcnt(0)
L2_p9_ok:
    s_waitcnt vmcnt(11)
    s_barrier
    s_waitcnt lgkmcnt(14)
    v_mfma_f32_16x16x32_bf16 v[112:115], v[16:19], v[192:195], v[112:115]
    s_add_u32 s64, s94, 0
    buffer_load_dwordx4 v[56:59], v2, s[44:47], s64 offen sc1
    s_add_u32 s64, s94, 8192
    buffer_load_dwordx4 v[60:63], v2, s[44:47], s64 offen sc1
    v_mfma_f32_16x16x32_bf16 v[144:147], v[16:19], v[196:199], v[144:147]
    ds_read_b64_tr_b16 v[48:49], v240 offset:24576
    ds_read_b64_tr_b16 v[50:51], v240 offset:28672
    s_add_u32 m0, s91, 0
    s_add_u32 s62, s86, 1212416
    buffer_load_dwordx4 v13, s[36:39], s62 offen lds
    s_add_u32 s64, s94, 16384
    buffer_load_dwordx4 v[64:67], v2, s[44:47], s64 offen sc1
    s_add_u32 s64, s94, 24576
    buffer_load_dwordx4 v[68:71], v2, s[44:47], s64 offen sc1
    s_waitcnt lgkmcnt(14)
    v_mfma_f32_16x16x32_bf16 v[148:151], v[20:23], v[196:199], v[148:151]
    s_add_u32 s64, s94, 32768
    buffer_load_dwordx4 v[72:75], v2, s[44:47], s64 offen sc1
    s_add_u32 s64, s94, 40960
    buffer_load_dwordx4 v[76:79], v2, s[44:47], s64 offen sc1
    v_mfma_f32_16x16x32_bf16 v[116:119], v[20:23], v[192:195], v[116:119]
    ds_read_b64_tr_b16 v[52:53], v241 offset:24576
    ds_read_b64_tr_b16 v[54:55], v241 offset:28672
    s_add_u32 s64, s94, 49152
    buffer_load_dwordx4 v[80:83], v2, s[44:47], s64 offen sc1
    s_add_u32 s64, s94, 57344
    buffer_load_dwordx4 v[84:87], v2, s[44:47], s64 offen sc1
    s_waitcnt lgkmcnt(14)
    v_mfma_f32_16x16x32_bf16 v[120:123], v[24:27], v[192:195], v[120:123]
    buffer_load_dwordx4 v[88:91], v7, s[44:47], s12 offen sc1
    v_mfma_f32_16x16x32_bf16 v[152:155], v[24:27], v[196:199], v[152:155]
    ds_read_b64_tr_b16 v[16:17], v242 offset:24576
    ds_read_b64_tr_b16 v[18:19], v242 offset:28672
    s_add_u32 s63, s89, 131072
    buffer_load_dwordx4 v[176:179], v2, s[44:47], s63 offen sc1
    s_waitcnt lgkmcnt(14)
    v_mfma_f32_16x16x32_bf16 v[156:159], v[28:31], v[196:199], v[156:159]
    v_mfma_f32_16x16x32_bf16 v[124:127], v[28:31], v[192:195], v[124:127]
    ds_read_b64_tr_b16 v[20:21], v243 offset:24576
    ds_read_b64_tr_b16 v[22:23], v243 offset:28672
    s_waitcnt lgkmcnt(14)
    v_mfma_f32_16x16x32_bf16 v[128:131], v[32:35], v[192:195], v[128:131]
    v_mfma_f32_16x16x32_bf16 v[160:163], v[32:35], v[196:199], v[160:163]
    ds_read_b64_tr_b16 v[24:25], v244 offset:24576
    ds_read_b64_tr_b16 v[26:27], v244 offset:28672
    buffer_load_dwordx4 v[180:183], v2, s[44:47], s63 offen offset:1024 sc1
    s_waitcnt lgkmcnt(14)
    v_mfma_f32_16x16x32_bf16 v[164:167], v[36:39], v[196:199], v[164:167]
    v_mfma_f32_16x16x32_bf16 v[132:135], v[36:39], v[192:195], v[132:135]
    ds_read_b64_tr_b16 v[28:29], v245 offset:24576
    ds_read_b64_tr_b16 v[30:31], v245 offset:28672
    s_waitcnt lgkmcnt(14)
    v_mfma_f32_16x16x32_bf16 v[136:139], v[40:43], v[192:195], v[136:139]
    v_mfma_f32_16x16x32_bf16 v[168:171], v[40:43], v[196:199], v[168:171]
    ds_read_b64_tr_b16 v[32:33], v246 offset:24576
    ds_read_b64_tr_b16 v[34:35], v246 offset:28672
    s_waitcnt lgkmcnt(14)
    v_mfma_f32_16x16x32_bf16 v[172:175], v[44:47], v[196:199], v[172:175]
    v_mfma_f32_16x16x32_bf16 v[140:143], v[44:47], v[192:195], v[140:143]
    ds_read_b64_tr_b16 v[36:37], v247 offset:24576
    ds_read_b64_tr_b16 v[38:39], v247 offset:28672
    s_waitcnt lgkmcnt(14)
    v_mfma_f32_16x16x32_bf16 v[112:115], v[48:51], v[200:203], v[112:115]
    v_mfma_f32_16x16x32_bf16 v[144:147], v[48:51], v[204:207], v[144:147]
    ds_read_b64_tr_b16 v[40:41], v240 offset:32768
    ds_read_b64_tr_b16 v[42:43], v240 offset:36864
    s_add_u32 m0, s91, 8192
    s_add_u32 s62, s86, 1277952
    buffer_load_dwordx4 v13, s[36:39], s62 offen lds
    s_waitcnt lgkmcnt(14)
    v_mfma_f32_16x16x32_bf16 v[148:151], v[52:55], v[204:207], v[148:151]
    v_mfma_f32_16x16x32_bf16 v[116:119], v[52:55], v[200:203], v[116:119]
    ds_read_b64_tr_b16 v[44:45], v241 offset:32768
    ds_read_b64_tr_b16 v[46:47], v241 offset:36864
    s_waitcnt lgkmcnt(14)
    v_mfma_f32_16x16x32_bf16 v[120:123], v[16:19], v[200:203], v[120:123]
    v_mfma_f32_16x16x32_bf16 v[152:155], v[16:19], v[204:207], v[152:155]
    ds_read_b64_tr_b16 v[48:49], v242 offset:32768
    ds_read_b64_tr_b16 v[50:51], v242 offset:36864
    s_add_u32 s63, s89, 139264
    buffer_load_dwordx4 v[184:187], v2, s[44:47], s63 offen sc1
    s_waitcnt lgkmcnt(14)
    v_mfma_f32_16x16x32_bf16 v[156:159], v[20:23], v[204:207], v[156:159]
    v_mfma_f32_16x16x32_bf16 v[124:127], v[20:23], v[200:203], v[124:127]
    ds_read_b64_tr_b16 v[52:53], v243 offset:32768
    ds_read_b64_tr_b16 v[54:55], v243 offset:36864
    s_waitcnt lgkmcnt(14)
    v_mfma_f32_16x16x32_bf16 v[128:131], v[24:27], v[200:203], v[128:131]
    v_mfma_f32_16x16x32_bf16 v[160:163], v[24:27], v[204:207], v[160:163]
    ds_read_b64_tr_b16 v[16:17], v244 offset:32768
    ds_read_b64_tr_b16 v[18:19], v244 offset:36864
    buffer_load_dwordx4 v[188:191], v2, s[44:47], s63 offen offset:1024 sc1
    s_waitcnt lgkmcnt(14)
    v_mfma_f32_16x16x32_bf16 v[164:167], v[28:31], v[204:207], v[164:167]
    v_mfma_f32_16x16x32_bf16 v[132:135], v[28:31], v[200:203], v[132:135]
    ds_read_b64_tr_b16 v[20:21], v245 offset:32768
    ds_read_b64_tr_b16 v[22:23], v245 offset:36864
    s_waitcnt lgkmcnt(14)
    v_mfma_f32_16x16x32_bf16 v[136:139], v[32:35], v[200:203], v[136:139]
    v_mfma_f32_16x16x32_bf16 v[168:171], v[32:35], v[204:207], v[168:171]
    ds_read_b64_tr_b16 v[24:25], v246 offset:32768
    ds_read_b64_tr_b16 v[26:27], v246 offset:36864
    s_waitcnt lgkmcnt(14)
    v_mfma_f32_16x16x32_bf16 v[172:175], v[36:39], v[204:207], v[172:175]
    v_mfma_f32_16x16x32_bf16 v[140:143], v[36:39], v[200:203], v[140:143]
    ds_read_b64_tr_b16 v[28:29], v247 offset:32768
    ds_read_b64_tr_b16 v[30:31], v247 offset:36864
    s_waitcnt vmcnt(20)
    s_barrier
    s_waitcnt lgkmcnt(14)
    v_mfma_f32_16x16x32_bf16 v[112:115], v[40:43], v[208:211], v[112:115]
    v_mfma_f32_16x16x32_bf16 v[144:147], v[40:43], v[212:215], v[144:147]
    ds_read_b64_tr_b16 v[32:33], v240 offset:40960
    ds_read_b64_tr_b16 v[34:35], v240 offset:45056
    s_add_u32 m0, s91, 16384
    s_add_u32 s62, s86, 1376256
    buffer_load_dwordx4 v13, s[36:39], s62 offen lds
    s_waitcnt lgkmcnt(14)
    v_mfma_f32_16x16x32_bf16 v[148:151], v[44:47], v[212:215], v[148:151]
    v_mfma_f32_16x16x32_bf16 v[116:119], v[44:47], v[208:211], v[116:119]
    ds_read_b64_tr_b16 v[36:37], v241 offset:40960
    ds_read_b64_tr_b16 v[38:39], v241 offset:45056
    s_waitcnt lgkmcnt(14)
    v_mfma_f32_16x16x32_bf16 v[120:123], v[48:51], v[208:211], v[120:123]
    v_mfma_f32_16x16x32_bf16 v[152:155], v[48:51], v[212:215], v[152:155]
    ds_read_b64_tr_b16 v[40:41], v242 offset:40960
    ds_read_b64_tr_b16 v[42:43], v242 offset:45056
    s_add_u32 s63, s89, 147456
    buffer_load_dwordx4 v[192:195], v2, s[44:47], s63 offen sc1
    s_waitcnt lgkmcnt(14)
    v_mfma_f32_16x16x32_bf16 v[156:159], v[52:55], v[212:215], v[156:159]
    v_mfma_f32_16x16x32_bf16 v[124:127], v[52:55], v[208:211], v[124:127]
    ds_read_b64_tr_b16 v[44:45], v243 offset:40960
    ds_read_b64_tr_b16 v[46:47], v243 offset:45056
    s_waitcnt lgkmcnt(14)
    v_mfma_f32_16x16x32_bf16 v[128:131], v[16:19], v[208:211], v[128:131]
    s_waitcnt vmcnt(7)
    s_nop 0
    v_add_f32_dpp v88, v88, v88 row_ror:1 row_mask:0xf bank_mask:0xf
    v_mfma_f32_16x16x32_bf16 v[160:163], v[16:19], v[212:215], v[160:163]
    ds_read_b64_tr_b16 v[48:49], v244 offset:40960
    ds_read_b64_tr_b16 v[50:51], v244 offset:45056
    buffer_load_dwordx4 v[196:199], v2, s[44:47], s63 offen offset:1024 sc1
    v_add_f32_dpp v89, v89, v89 row_ror:1 row_mask:0xf bank_mask:0xf
    v_add_f32_dpp v90, v90, v90 row_ror:1 row_mask:0xf bank_mask:0xf
    s_waitcnt lgkmcnt(14)
    v_mfma_f32_16x16x32_bf16 v[164:167], v[20:23], v[212:215], v[164:167]
    v_add_f32_dpp v91, v91, v91 row_ror:1 row_mask:0xf bank_mask:0xf
    v_add_f32 v56, v56, v72
    v_mfma_f32_16x16x32_bf16 v[132:135], v[20:23], v[208:211], v[132:135]
    ds_read_b64_tr_b16 v[52:53], v245 offset:40960
    ds_read_b64_tr_b16 v[54:55], v245 offset:45056
    v_add_f32 v57, v57, v73
    v_add_f32 v58, v58, v74
    s_waitcnt lgkmcnt(14)
    v_mfma_f32_16x16x32_bf16 v[136:139], v[24:27], v[208:211], v[136:139]
    v_add_f32 v59, v59, v75
    v_add_f32 v60, v60, v76
    v_mfma_f32_16x16x32_bf16 v[168:171], v[24:27], v[212:215], v[168:171]
    ds_read_b64_tr_b16 v[16:17], v246 offset:40960
    ds_read_b64_tr_b16 v[18:19], v246 offset:45056
    v_add_f32 v61, v61, v77
    v_add_f32 v62, v62, v78
    s_waitcnt lgkmcnt(14)
    v_mfma_f32_16x16x32_bf16 v[172:175], v[28:31], v[212:215], v[172:175]
    v_add_f32 v63, v63, v79
    v_add_f32 v64, v64, v80
    v_mfma_f32_16x16x32_bf16 v[140:143], v[28:31], v[208:211], v[140:143]
    ds_read_b64_tr_b16 v[20:21], v247 offset:40960
    ds_read_b64_tr_b16 v[22:23], v247 offset:45056
    v_add_f32 v65, v65, v81
    v_add_f32 v66, v66, v82
    s_waitcnt lgkmcnt(14)
    v_mfma_f32_16x16x32_bf16 v[112:115], v[32:35], v[216:219], v[112:115]
    v_add_f32 v67, v67, v83
    v_add_f32 v68, v68, v84
    v_mfma_f32_16x16x32_bf16 v[144:147], v[32:35], v[220:223], v[144:147]
    ds_read_b64_tr_b16 v[24:25], v240 offset:49152
    ds_read_b64_tr_b16 v[26:27], v240 offset:53248
    s_add_u32 m0, s91, 24576
    s_add_u32 s62, s86, 1441792
    buffer_load_dwordx4 v13, s[36:39], s62 offen lds
    v_add_f32 v69, v69, v85
    v_add_f32 v70, v70, v86
    s_waitcnt lgkmcnt(14)
    v_mfma_f32_16x16x32_bf16 v[148:151], v[36:39], v[220:223], v[148:151]
    v_add_f32 v71, v71, v87
    v_add_f32_dpp v88, v88, v88 row_ror:2 row_mask:0xf bank_mask:0xf
    v_mfma_f32_16x16x32_bf16 v[116:119], v[36:39], v[216:219], v[116:119]
    ds_read_b64_tr_b16 v[28:29], v241 offset:49152
    ds_read_b64_tr_b16 v[30:31], v241 offset:53248
    v_add_f32_dpp v89, v89, v89 row_ror:2 row_mask:0xf bank_mask:0xf
    v_add_f32_dpp v90, v90, v90 row_ror:2 row_mask:0xf bank_mask:0xf
    s_waitcnt lgkmcnt(14)
    v_mfma_f32_16x16x32_bf16 v[120:123], v[40:43], v[216:219], v[120:123]
    v_add_f32_dpp v91, v91, v91 row_ror:2 row_mask:0xf bank_mask:0xf
    v_add_f32 v56, v56, v64
    v_mfma_f32_16x16x32_bf16 v[152:155], v[40:43], v[220:223], v[152:155]
    ds_read_b64_tr_b16 v[32:33], v242 offset:49152
    ds_read_b64_tr_b16 v[34:35], v242 offset:53248
    s_add_u32 s63, s89, 155648
    buffer_load_dwordx4 v[200:203], v2, s[44:47], s63 offen sc1
    v_add_f32 v57, v57, v65
    v_add_f32 v58, v58, v66
    s_waitcnt lgkmcnt(14)
    v_mfma_f32_16x16x32_bf16 v[156:159], v[44:47], v[220:223], v[156:159]
    v_add_f32 v59, v59, v67
    v_add_f32 v60, v60, v68
    v_mfma_f32_16x16x32_bf16 v[124:127], v[44:47], v[216:219], v[124:127]
    ds_read_b64_tr_b16 v[36:37], v243 offset:49152
    ds_read_b64_tr_b16 v[38:39], v243 offset:53248
    v_add_f32 v61, v61, v69
    v_add_f32 v62, v62, v70
    s_waitcnt lgkmcnt(14)
    v_mfma_f32_16x16x32_bf16 v[128:131], v[48:51], v[216:219], v[128:131]
    v_add_f32 v63, v63, v71
    v_add_f32 v56, v56, v60
    v_mfma_f32_16x16x32_bf16 v[160:163], v[48:51], v[220:223], v[160:163]
    ds_read_b64_tr_b16 v[40:41], v244 offset:49152
    ds_read_b64_tr_b16 v[42:43], v244 offset:53248
    buffer_load_dwordx4 v[204:207], v2, s[44:47], s63 offen offset:1024 sc1
    v_add_f32 v57, v57, v61
    v_add_f32 v58, v58, v62
    s_waitcnt lgkmcnt(14)
    v_mfma_f32_16x16x32_bf16 v[164:167], v[52:55], v[220:223], v[164:167]
    v_add_f32 v59, v59, v63
    v_add_f32_dpp v88, v88, v88 row_ror:4 row_mask:0xf bank_mask:0xf
    v_mfma_f32_16x16x32_bf16 v[132:135], v[52:55], v[216:219], v[132:135]
    ds_read_b64_tr_b16 v[44:45], v245 offset:49152
    ds_read_b64_tr_b16 v[46:47], v245 offset:53248
    v_add_f32_dpp v89, v89, v89 row_ror:4 row_mask:0xf bank_mask:0xf
    v_add_f32_dpp v90, v90, v90 row_ror:4 row_mask:0xf bank_mask:0xf
    s_waitcnt lgkmcnt(14)
    v_mfma_f32_16x16x32_bf16 v[136:139], v[16:19], v[216:219], v[136:139]
    v_add_f32_dpp v91, v91, v91 row_ror:4 row_mask:0xf bank_mask:0xf
    v_cvt_pk_bf16_f32 v60, v56, v57
    v_mfma_f32_16x16x32_bf16 v[168:171], v[16:19], v[220:223], v[168:171]
    ds_read_b64_tr_b16 v[48:49], v246 offset:49152
    ds_read_b64_tr_b16 v[50:51], v246 offset:53248
    v_cvt_pk_bf16_f32 v64, v88, v89
    v_cvt_pk_bf16_f32 v61, v58, v59
    s_waitcnt lgkmcnt(14)
    v_mfma_f32_16x16x32_bf16 v[172:175], v[20:23], v[220:223], v[172:175]
    v_cvt_pk_bf16_f32 v65, v90, v91
    ds_write_b64 v5, v[60:61]
    v_mfma_f32_16x16x32_bf16 v[140:143], v[20:23], v[216:219], v[140:143]
    ds_read_b64_tr_b16 v[52:53], v247 offset:49152
    ds_read_b64_tr_b16 v[54:55], v247 offset:53248
    ds_write_b64 v6, v[64:65] offset:4096
    s_waitcnt lgkmcnt(0)
    s_barrier
    v_mfma_f32_16x16x32_bf16 v[112:115], v[24:27], v[224:227], v[112:115]
    ds_read_b128 v[72:75], v2 offset:53248
    ds_read_b128 v[76:79], v2 offset:54272
    v_mfma_f32_16x16x32_bf16 v[144:147], v[24:27], v[228:231], v[144:147]
    ds_read_b64_tr_b16 v[16:17], v240 offset:57344
    ds_read_b64_tr_b16 v[18:19], v240 offset:61440
    s_add_u32 m0, s91, 32768
    s_add_u32 s62, s86, 1507328
    buffer_load_dwordx4 v13, s[36:39], s62 offen lds
    ds_read_b128 v[56:59], v2 offset:49152
    ds_read_b128 v[60:63], v2 offset:50176
    v_mfma_f32_16x16x32_bf16 v[148:151], v[28:31], v[228:231], v[148:151]
    ds_read_b128 v[64:67], v2 offset:51200
    ds_read_b128 v[68:71], v2 offset:52224
    v_mfma_f32_16x16x32_bf16 v[116:119], v[28:31], v[224:227], v[116:119]
    ds_read_b64_tr_b16 v[20:21], v241 offset:57344
    ds_read_b64_tr_b16 v[22:23], v241 offset:61440
    s_mov_b32 s65, 0x358637bd
    v_mfma_f32_16x16x32_bf16 v[120:123], v[32:35], v[224:227], v[120:123]
    v_mfma_f32_16x16x32_bf16 v[152:155], v[32:35], v[228:231], v[152:155]
    ds_read_b64_tr_b16 v[24:25], v242 offset:57344
    ds_read_b64_tr_b16 v[26:27], v242 offset:61440
    s_add_u32 s63, s89, 163840
    buffer_load_dwordx4 v[208:211], v2, s[44:47], s63 offen sc1
    v_mfma_f32_16x16x32_bf16 v[156:159], v[36:39], v[228:231], v[156:159]
    s_waitcnt lgkmcnt(11)
    v_mfma_f32_16x16x32_bf16 v[248:251], v[72:75], v[96:99], 0
    v_mfma_f32_16x16x32_bf16 v[8:11], v[72:75], v[104:107], 0
    v_mfma_f32_16x16x32_bf16 v[124:127], v[36:39], v[224:227], v[124:127]
    ds_read_b64_tr_b16 v[28:29], v243 offset:57344
    ds_read_b64_tr_b16 v[30:31], v243 offset:61440
    s_waitcnt lgkmcnt(12)
    v_mfma_f32_16x16x32_bf16 v[248:251], v[76:79], v[100:103], v[248:251]
    v_mfma_f32_16x16x32_bf16 v[8:11], v[76:79], v[108:111], v[8:11]
    v_mfma_f32_16x16x32_bf16 v[128:131], v[40:43], v[224:227], v[128:131]
    s_waitcnt lgkmcnt(9)
    v_mfma_f32_16x16x32_bf16 v[80:83], v[56:59], v[96:99], 0
    v_mfma_f32_16x16x32_bf16 v[88:91], v[56:59], v[104:107], 0
    v_mfma_f32_16x16x32_bf16 v[160:163], v[40:43], v[228:231], v[160:163]
    ds_read_b64_tr_b16 v[32:33], v244 offset:57344
    ds_read_b64_tr_b16 v[34:35], v244 offset:61440
    buffer_load_dwordx4 v[212:215], v2, s[44:47], s63 offen offset:1024 sc1
    s_waitcnt lgkmcnt(10)
    v_mfma_f32_16x16x32_bf16 v[80:83], v[60:63], v[100:103], v[80:83]
    v_mfma_f32_16x16x32_bf16 v[88:91], v[60:63], v[108:111], v[88:91]
    v_mfma_f32_16x16x32_bf16 v[164:167], v[44:47], v[228:231], v[164:167]
    s_waitcnt lgkmcnt(9)
    v_mfma_f32_16x16x32_bf16 v[84:87], v[64:67], v[96:99], 0
    v_mfma_f32_16x16x32_bf16 v[92:95], v[64:67], v[104:107], 0
    v_mfma_f32_16x16x32_bf16 v[132:135], v[44:47], v[224:227], v[132:135]
    ds_read_b64_tr_b16 v[36:37], v245 offset:57344
    ds_read_b64_tr_b16 v[38:39], v245 offset:61440
    s_waitcnt lgkmcnt(10)
    v_mfma_f32_16x16x32_bf16 v[84:87], v[68:71], v[100:103], v[84:87]
    v_mfma_f32_16x16x32_bf16 v[92:95], v[68:71], v[108:111], v[92:95]
    v_mfma_f32_16x16x32_bf16 v[136:139], v[48:51], v[224:227], v[136:139]
    v_add_f32 v248, s65, v248
    v_add_f32 v8, s65, v8
    v_mfma_f32_16x16x32_bf16 v[168:171], v[48:51], v[228:231], v[168:171]
    ds_read_b64_tr_b16 v[40:41], v246 offset:57344
    ds_read_b64_tr_b16 v[42:43], v246 offset:61440
    v_rcp_f32 v248, v248
    v_rcp_f32 v8, v8
    v_mfma_f32_16x16x32_bf16 v[172:175], v[52:55], v[228:231], v[172:175]
    v_mov_b32 v249, v248
    v_mfma_f32_16x16x32_bf16 v[140:143], v[52:55], v[224:227], v[140:143]
    ds_read_b64_tr_b16 v[44:45], v247 offset:57344
    ds_read_b64_tr_b16 v[46:47], v247 offset:61440
    v_mov_b32 v9, v8
    v_mul_f32 v80, v80, v248
    v_mfma_f32_16x16x32_bf16 v[112:115], v[16:19], v[232:235], v[112:115]
    v_mul_f32 v81, v81, v249
    v_mul_f32 v82, v82, v248
    v_mfma_f32_16x16x32_bf16 v[144:147], v[16:19], v[236:239], v[144:147]
    ds_read_b64_tr_b16 v[48:49], v240 offset:0
    ds_read_b64_tr_b16 v[50:51], v240 offset:4096
    s_add_u32 m0, s91, 40960
    s_add_u32 s62, s86, 1605632
    buffer_load_dwordx4 v13, s[36:39], s62 offen lds
    v_mul_f32 v83, v83, v249
    v_mul_f32 v84, v84, v248
    s_waitcnt lgkmcnt(14)
    v_mfma_f32_16x16x32_bf16 v[148:151], v[20:23], v[236:239], v[148:151]
    v_mul_f32 v85, v85, v249
    v_mul_f32 v86, v86, v248
    v_mfma_f32_16x16x32_bf16 v[116:119], v[20:23], v[232:235], v[116:119]
    ds_read_b64_tr_b16 v[52:53], v241 offset:0
    ds_read_b64_tr_b16 v[54:55], v241 offset:4096
    v_mul_f32 v87, v87, v249
    v_mul_f32 v88, v88, v8
    s_waitcnt lgkmcnt(14)
    v_mfma_f32_16x16x32_bf16 v[120:123], v[24:27], v[232:235], v[120:123]
    v_mul_f32 v89, v89, v9
    v_mul_f32 v90, v90, v8
    v_mfma_f32_16x16x32_bf16 v[152:155], v[24:27], v[236:239], v[152:155]
    ds_read_b64_tr_b16 v[16:17], v242 offset:0
    ds_read_b64_tr_b16 v[18:19], v242 offset:4096
    s_add_u32 s63, s89, 172032
    buffer_load_dwordx4 v[216:219], v2, s[44:47], s63 offen sc1
    v_mul_f32 v91, v91, v9
    v_mul_f32 v92, v92, v8
    s_waitcnt lgkmcnt(14)
    v_mfma_f32_16x16x32_bf16 v[156:159], v[28:31], v[236:239], v[156:159]
    v_mul_f32 v93, v93, v9
    v_mul_f32 v94, v94, v8
    v_mfma_f32_16x16x32_bf16 v[124:127], v[28:31], v[232:235], v[124:127]
    ds_read_b64_tr_b16 v[20:21], v243 offset:0
    ds_read_b64_tr_b16 v[22:23], v243 offset:4096
    v_mul_f32 v95, v95, v9
    v_cvt_pk_bf16_f32 v80, v80, v81
    s_waitcnt lgkmcnt(14)
    v_mfma_f32_16x16x32_bf16 v[128:131], v[32:35], v[232:235], v[128:131]
    v_cvt_pk_bf16_f32 v81, v82, v83
    v_cvt_pk_bf16_f32 v82, v84, v85
    v_mfma_f32_16x16x32_bf16 v[160:163], v[32:35], v[236:239], v[160:163]
    ds_read_b64_tr_b16 v[24:25], v244 offset:0
    ds_read_b64_tr_b16 v[26:27], v244 offset:4096
    buffer_load_dwordx4 v[220:223], v2, s[44:47], s63 offen offset:1024 sc1
    v_cvt_pk_bf16_f32 v83, v86, v87
    buffer_store_dwordx4 v[80:83], v2, s[44:47], s93 offen offset:0
    s_waitcnt lgkmcnt(14)
    v_mfma_f32_16x16x32_bf16 v[164:167], v[36:39], v[236:239], v[164:167]
    v_cvt_pk_bf16_f32 v88, v88, v89
    v_cvt_pk_bf16_f32 v89, v90, v91
    v_mfma_f32_16x16x32_bf16 v[132:135], v[36:39], v[232:235], v[132:135]
    ds_read_b64_tr_b16 v[28:29], v245 offset:0
    ds_read_b64_tr_b16 v[30:31], v245 offset:4096
    v_cvt_pk_bf16_f32 v90, v92, v93
    v_cvt_pk_bf16_f32 v91, v94, v95
    s_waitcnt lgkmcnt(14)
    v_mfma_f32_16x16x32_bf16 v[136:139], v[40:43], v[232:235], v[136:139]
    buffer_store_dwordx4 v[88:91], v2, s[44:47], s93 offen offset:1024
    v_mfma_f32_16x16x32_bf16 v[168:171], v[40:43], v[236:239], v[168:171]
    ds_read_b64_tr_b16 v[32:33], v246 offset:0
    ds_read_b64_tr_b16 v[34:35], v246 offset:4096
    s_waitcnt lgkmcnt(14)
    v_mfma_f32_16x16x32_bf16 v[172:175], v[44:47], v[236:239], v[172:175]
    v_mfma_f32_16x16x32_bf16 v[140:143], v[44:47], v[232:235], v[140:143]
    ds_read_b64_tr_b16 v[36:37], v247 offset:0
    ds_read_b64_tr_b16 v[38:39], v247 offset:4096
    s_waitcnt vmcnt(13)
    s_barrier
    s_waitcnt lgkmcnt(14)
    v_mfma_f32_16x16x32_bf16 v[112:115], v[48:51], v[176:179], v[112:115]
    v_mfma_f32_16x16x32_bf16 v[144:147], v[48:51], v[180:183], v[144:147]
    ds_read_b64_tr_b16 v[40:41], v240 offset:8192
    ds_read_b64_tr_b16 v[42:43], v240 offset:12288
    s_add_u32 m0, s91, 49152
    s_add_u32 s62, s86, 1671168
    buffer_load_dwordx4 v13, s[36:39], s62 offen lds
    s_waitcnt lgkmcnt(14)
    v_mfma_f32_16x16x32_bf16 v[148:151], v[52:55], v[180:183], v[148:151]
    v_mfma_f32_16x16x32_bf16 v[116:119], v[52:55], v[176:179], v[116:119]
    ds_read_b64_tr_b16 v[44:45], v241 offset:8192
    ds_read_b64_tr_b16 v[46:47], v241 offset:12288
    s_waitcnt lgkmcnt(14)
    v_mfma_f32_16x16x32_bf16 v[120:123], v[16:19], v[176:179], v[120:123]
    s_add_u32 m0, s91, 4294901760
    s_add_u32 s62, s88, 131072
    buffer_load_dwordx4 v13, s[76:79], s62 offen lds
    v_mfma_f32_16x16x32_bf16 v[152:155], v[16:19], v[180:183], v[152:155]
    ds_read_b64_tr_b16 v[48:49], v242 offset:8192
    ds_read_b64_tr_b16 v[50:51], v242 offset:12288
    s_waitcnt lgkmcnt(14)
    v_mfma_f32_16x16x32_bf16 v[156:159], v[20:23], v[180:183], v[156:159]
    v_mfma_f32_16x16x32_bf16 v[124:127], v[20:23], v[176:179], v[124:127]
    ds_read_b64_tr_b16 v[52:53], v243 offset:8192
    ds_read_b64_tr_b16 v[54:55], v243 offset:12288
    s_add_u32 s63, s89, 180224
    buffer_load_dwordx4 v[224:227], v2, s[44:47], s63 offen sc1
    s_waitcnt lgkmcnt(14)
    v_mfma_f32_16x16x32_bf16 v[128:131], v[24:27], v[176:179], v[128:131]
    v_mfma_f32_16x16x32_bf16 v[160:163], v[24:27], v[180:183], v[160:163]
    ds_read_b64_tr_b16 v[16:17], v244 offset:8192
    ds_read_b64_tr_b16 v[18:19], v244 offset:12288
    s_waitcnt lgkmcnt(14)
    v_mfma_f32_16x16x32_bf16 v[164:167], v[28:31], v[180:183], v[164:167]
    buffer_load_dwordx4 v[228:231], v2, s[44:47], s63 offen offset:1024 sc1
    v_mfma_f32_16x16x32_bf16 v[132:135], v[28:31], v[176:179], v[132:135]
    ds_read_b64_tr_b16 v[20:21], v245 offset:8192
    ds_read_b64_tr_b16 v[22:23], v245 offset:12288
    s_waitcnt lgkmcnt(14)
    v_mfma_f32_16x16x32_bf16 v[136:139], v[32:35], v[176:179], v[136:139]
    v_mfma_f32_16x16x32_bf16 v[168:171], v[32:35], v[180:183], v[168:171]
    ds_read_b64_tr_b16 v[24:25], v246 offset:8192
    ds_read_b64_tr_b16 v[26:27], v246 offset:12288
    s_waitcnt lgkmcnt(14)
    v_mfma_f32_16x16x32_bf16 v[172:175], v[36:39], v[180:183], v[172:175]
    v_mfma_f32_16x16x32_bf16 v[140:143], v[36:39], v[176:179], v[140:143]
    ds_read_b64_tr_b16 v[28:29], v247 offset:8192
    ds_read_b64_tr_b16 v[30:31], v247 offset:12288
    s_waitcnt lgkmcnt(14)
    v_mfma_f32_16x16x32_bf16 v[112:115], v[40:43], v[184:187], v[112:115]
    v_mfma_f32_16x16x32_bf16 v[144:147], v[40:43], v[188:191], v[144:147]
    ds_read_b64_tr_b16 v[32:33], v240 offset:16384
    ds_read_b64_tr_b16 v[34:35], v240 offset:20480
    s_add_u32 m0, s91, 57344
    s_add_u32 s62, s86, 1736704
    buffer_load_dwordx4 v13, s[36:39], s62 offen lds
    s_waitcnt lgkmcnt(14)
    v_mfma_f32_16x16x32_bf16 v[148:151], v[44:47], v[188:191], v[148:151]
    v_mfma_f32_16x16x32_bf16 v[116:119], v[44:47], v[184:187], v[116:119]
    ds_read_b64_tr_b16 v[36:37], v241 offset:16384
    ds_read_b64_tr_b16 v[38:39], v241 offset:20480
    s_waitcnt lgkmcnt(14)
    v_mfma_f32_16x16x32_bf16 v[120:123], v[48:51], v[184:187], v[120:123]
    s_add_u32 m0, s91, 4294909952
    s_add_u32 s62, s88, 196608
    buffer_load_dwordx4 v13, s[76:79], s62 offen lds
    v_mfma_f32_16x16x32_bf16 v[152:155], v[48:51], v[188:191], v[152:155]
    ds_read_b64_tr_b16 v[40:41], v242 offset:16384
    ds_read_b64_tr_b16 v[42:43], v242 offset:20480
    s_waitcnt lgkmcnt(14)
    v_mfma_f32_16x16x32_bf16 v[156:159], v[52:55], v[188:191], v[156:159]
    v_mfma_f32_16x16x32_bf16 v[124:127], v[52:55], v[184:187], v[124:127]
    ds_read_b64_tr_b16 v[44:45], v243 offset:16384
    ds_read_b64_tr_b16 v[46:47], v243 offset:20480
    s_add_u32 s63, s89, 188416
    buffer_load_dwordx4 v[232:235], v2, s[44:47], s63 offen sc1
    s_waitcnt lgkmcnt(14)
    v_mfma_f32_16x16x32_bf16 v[128:131], v[16:19], v[184:187], v[128:131]
    v_mfma_f32_16x16x32_bf16 v[160:163], v[16:19], v[188:191], v[160:163]
    ds_read_b64_tr_b16 v[48:49], v244 offset:16384
    ds_read_b64_tr_b16 v[50:51], v244 offset:20480
    s_waitcnt lgkmcnt(14)
    v_mfma_f32_16x16x32_bf16 v[164:167], v[20:23], v[188:191], v[164:167]
    buffer_load_dwordx4 v[236:239], v2, s[44:47], s63 offen offset:1024 sc1
    v_mfma_f32_16x16x32_bf16 v[132:135], v[20:23], v[184:187], v[132:135]
    ds_read_b64_tr_b16 v[52:53], v245 offset:16384
    ds_read_b64_tr_b16 v[54:55], v245 offset:20480
    s_waitcnt lgkmcnt(14)
    v_mfma_f32_16x16x32_bf16 v[136:139], v[24:27], v[184:187], v[136:139]
    v_mfma_f32_16x16x32_bf16 v[168:171], v[24:27], v[188:191], v[168:171]
    ds_read_b64_tr_b16 v[16:17], v246 offset:16384
    ds_read_b64_tr_b16 v[18:19], v246 offset:20480
    s_waitcnt lgkmcnt(14)
    v_mfma_f32_16x16x32_bf16 v[172:175], v[28:31], v[188:191], v[172:175]
    v_mfma_f32_16x16x32_bf16 v[140:143], v[28:31], v[184:187], v[140:143]
    ds_read_b64_tr_b16 v[20:21], v247 offset:16384
    ds_read_b64_tr_b16 v[22:23], v247 offset:20480
    s_waitcnt vmcnt(8)
    s_barrier
    s_cmp_eq_u32 s20, 4
    s_cbranch_scc0 L2_f4
    s_cmp_lg_u32 s83, 0
    s_cbranch_scc1 L2_f4_s
    buffer_wbl2 sc1
    s_waitcnt vmcnt(0)
L2_f4_s:
    v_mov_b32 v254, 4
    s_mov_b64 exec, 1
    buffer_store_dword v254, off, s[44:47], s3 sc1
    s_mov_b64 exec, -1
L2_f4:
    s_waitcnt lgkmcnt(14)
    v_mfma_f32_16x16x32_bf16 v[112:115], v[32:35], v[192:195], v[112:115]
    v_and_b32 v252, 31, v1
    s_andn2_b32 s68, s3, 0xf80
    v_mfma_f32_16x16x32_bf16 v[144:147], v[32:35], v[196:199], v[144:147]
    ds_read_b64_tr_b16 v[24:25], v240 offset:24576
    ds_read_b64_tr_b16 v[26:27], v240 offset:28672
    s_add_u32 m0, s91, 0
    s_add_u32 s62, s87, 0
    buffer_load_dwordx4 v13, s[36:39], s62 offen lds
    v_lshl_add_u32 v252, v252, 7, s68
    s_waitcnt lgkmcnt(14)
    v_mfma_f32_16x16x32_bf16 v[148:151], v[36:39], v[196:199], v[148:151]
    v_mfma_f32_16x16x32_bf16 v[116:119], v[36:39], v[192:195], v[116:119]
    ds_read_b64_tr_b16 v[28:29], v241 offset:24576
    ds_read_b64_tr_b16 v[30:31], v241 offset:28672
    s_waitcnt lgkmcnt(14)
    v_mfma_f32_16x16x32_bf16 v[120:123], v[40:43], v[192:195], v[120:123]
    s_add_u32 m0, s91, 4294918144
    s_add_u32 s62, s88, 262144
    buffer_load_dwordx4 v13, s[76:79], s62 offen lds
    v_mfma_f32_16x16x32_bf16 v[152:155], v[40:43], v[196:199], v[152:155]
    ds_read_b64_tr_b16 v[32:33], v242 offset:24576
    ds_read_b64_tr_b16 v[34:35], v242 offset:28672
    s_waitcnt lgkmcnt(14)
    v_mfma_f32_16x16x32_bf16 v[156:159], v[44:47], v[196:199], v[156:159]
    v_mfma_f32_16x16x32_bf16 v[124:127], v[44:47], v[192:195], v[124:127]
    ds_read_b64_tr_b16 v[36:37], v243 offset:24576
    ds_read_b64_tr_b16 v[38:39], v243 offset:28672
    s_add_u32 s63, s90, 0
    buffer_load_dwordx4 v[176:179], v2, s[44:47], s63 offen sc1
    s_waitcnt lgkmcnt(14)
    v_mfma_f32_16x16x32_bf16 v[128:131], v[48:51], v[192:195], v[128:131]
    v_mfma_f32_16x16x32_bf16 v[160:163], v[48:51], v[196:199], v[160:163]
    ds_read_b64_tr_b16 v[40:41], v244 offset:24576
    ds_read_b64_tr_b16 v[42:43], v244 offset:28672
    s_waitcnt lgkmcnt(14)
    v_mfma_f32_16x16x32_bf16 v[164:167], v[52:55], v[196:199], v[164:167]
    buffer_load_dwordx4 v[180:183], v2, s[44:47], s63 offen offset:1024 sc1
    v_mfma_f32_16x16x32_bf16 v[132:135], v[52:55], v[192:195], v[132:135]
    ds_read_b64_tr_b16 v[44:45], v245 offset:24576
    ds_read_b64_tr_b16 v[46:47], v245 offset:28672
    s_waitcnt lgkmcnt(14)
    v_mfma_f32_16x16x32_bf16 v[136:139], v[16:19], v[192:195], v[136:139]
    v_mfma_f32_16x16x32_bf16 v[168:171], v[16:19], v[196:199], v[168:171]
    ds_read_b64_tr_b16 v[48:49], v246 offset:24576
    ds_read_b64_tr_b16 v[50:51], v246 offset:28672
    s_waitcnt lgkmcnt(14)
    v_mfma_f32_16x16x32_bf16 v[172:175], v[20:23], v[196:199], v[172:175]
    v_mfma_f32_16x16x32_bf16 v[140:143], v[20:23], v[192:195], v[140:143]
    ds_read_b64_tr_b16 v[52:53], v247 offset:24576
    ds_read_b64_tr_b16 v[54:55], v247 offset:28672
    s_waitcnt lgkmcnt(14)
    v_mfma_f32_16x16x32_bf16 v[112:115], v[24:27], v[200:203], v[112:115]
    v_mfma_f32_16x16x32_bf16 v[144:147], v[24:27], v[204:207], v[144:147]
    ds_read_b64_tr_b16 v[16:17], v240 offset:32768
    ds_read_b64_tr_b16 v[18:19], v240 offset:36864
    s_add_u32 m0, s91, 8192
    s_add_u32 s62, s87, 458752
    buffer_load_dwordx4 v13, s[36:39], s62 offen lds
    s_waitcnt lgkmcnt(14)
    v_mfma_f32_16x16x32_bf16 v[148:151], v[28:31], v[204:207], v[148:151]
    v_mfma_f32_16x16x32_bf16 v[116:119], v[28:31], v[200:203], v[116:119]
    ds_read_b64_tr_b16 v[20:21], v241 offset:32768
    ds_read_b64_tr_b16 v[22:23], v241 offset:36864
    s_waitcnt lgkmcnt(14)
    v_mfma_f32_16x16x32_bf16 v[120:123], v[32:35], v[200:203], v[120:123]
    s_add_u32 m0, s91, 4294926336
    s_add_u32 s62, s88, 327680
    buffer_load_dwordx4 v13, s[76:79], s62 offen lds
    v_mfma_f32_16x16x32_bf16 v[152:155], v[32:35], v[204:207], v[152:155]
    ds_read_b64_tr_b16 v[24:25], v242 offset:32768
    ds_read_b64_tr_b16 v[26:27], v242 offset:36864
    s_waitcnt lgkmcnt(14)
    v_mfma_f32_16x16x32_bf16 v[156:159], v[36:39], v[204:207], v[156:159]
    v_mfma_f32_16x16x32_bf16 v[124:127], v[36:39], v[200:203], v[124:127]
    ds_read_b64_tr_b16 v[28:29], v243 offset:32768
    ds_read_b64_tr_b16 v[30:31], v243 offset:36864
    s_add_u32 s63, s90, 8192
    buffer_load_dwordx4 v[184:187], v2, s[44:47], s63 offen sc1
    s_waitcnt lgkmcnt(14)
    v_mfma_f32_16x16x32_bf16 v[128:131], v[40:43], v[200:203], v[128:131]
    v_mfma_f32_16x16x32_bf16 v[160:163], v[40:43], v[204:207], v[160:163]
    ds_read_b64_tr_b16 v[32:33], v244 offset:32768
    ds_read_b64_tr_b16 v[34:35], v244 offset:36864
    s_waitcnt lgkmcnt(14)
    v_mfma_f32_16x16x32_bf16 v[164:167], v[44:47], v[204:207], v[164:167]
    buffer_load_dwordx4 v[188:191], v2, s[44:47], s63 offen offset:1024 sc1
    v_mfma_f32_16x16x32_bf16 v[132:135], v[44:47], v[200:203], v[132:135]
    ds_read_b64_tr_b16 v[36:37], v245 offset:32768
    ds_read_b64_tr_b16 v[38:39], v245 offset:36864
    s_waitcnt lgkmcnt(14)
    v_mfma_f32_16x16x32_bf16 v[136:139], v[48:51], v[200:203], v[136:139]
    v_mfma_f32_16x16x32_bf16 v[168:171], v[48:51], v[204:207], v[168:171]
    ds_read_b64_tr_b16 v[40:41], v246 offset:32768
    ds_read_b64_tr_b16 v[42:43], v246 offset:36864
    s_waitcnt lgkmcnt(14)
    v_mfma_f32_16x16x32_bf16 v[172:175], v[52:55], v[204:207], v[172:175]
    v_mfma_f32_16x16x32_bf16 v[140:143], v[52:55], v[200:203], v[140:143]
    ds_read_b64_tr_b16 v[44:45], v247 offset:32768
    ds_read_b64_tr_b16 v[46:47], v247 offset:36864
    s_waitcnt vmcnt(15)
    s_barrier
    s_cmp_eq_u32 s20, 5
    s_cbranch_scc0 L2_q20
    buffer_load_dword v254, v252, s[44:47], 0 offen sc1
L2_q20:
    s_waitcnt lgkmcnt(14)
    v_mfma_f32_16x16x32_bf16 v[112:115], v[16:19], v[208:211], v[112:115]
    v_mfma_f32_16x16x32_bf16 v[144:147], v[16:19], v[212:215], v[144:147]
    ds_read_b64_tr_b16 v[48:49], v240 offset:40960
    ds_read_b64_tr_b16 v[50:51], v240 offset:45056
    s_add_u32 m0, s91, 16384
    s_add_u32 s62, s87, 917504
    buffer_load_dwordx4 v13, s[36:39], s62 offen lds
    s_waitcnt lgkmcnt(14)
    v_mfma_f32_16x16x32_bf16 v[148:151], v[20:23], v[212:215], v[148:151]
    v_mfma_f32_16x16x32_bf16 v[116:119], v[20:23], v[208:211], v[116:119]
    ds_read_b64_tr_b16 v[52:53], v241 offset:40960
    ds_read_b64_tr_b16 v[54:55], v241 offset:45056
    s_waitcnt lgkmcnt(14)
    v_mfma_f32_16x16x32_bf16 v[120:123], v[24:27], v[208:211], v[120:123]
    s_add_u32 m0, s91, 4294934528
    s_add_u32 s62, s88, 393216
    buffer_load_dwordx4 v13, s[76:79], s62 offen lds
    v_mfma_f32_16x16x32_bf16 v[152:155], v[24:27], v[212:215], v[152:155]
    ds_read_b64_tr_b16 v[16:17], v242 offset:40960
    ds_read_b64_tr_b16 v[18:19], v242 offset:45056
    s_waitcnt lgkmcnt(14)
    v_mfma_f32_16x16x32_bf16 v[156:159], v[28:31], v[212:215], v[156:159]
    v_mfma_f32_16x16x32_bf16 v[124:127], v[28:31], v[208:211], v[124:127]
    ds_read_b64_tr_b16 v[20:21], v243 offset:40960
    ds_read_b64_tr_b16 v[22:23], v243 offset:45056
    s_add_u32 s63, s90, 16384
    buffer_load_dwordx4 v[192:195], v2, s[44:47], s63 offen sc1
    s_waitcnt lgkmcnt(14)
    v_mfma_f32_16x16x32_bf16 v[128:131], v[32:35], v[208:211], v[128:131]
    v_mfma_f32_16x16x32_bf16 v[160:163], v[32:35], v[212:215], v[160:163]
    ds_read_b64_tr_b16 v[24:25], v244 offset:40960
    ds_read_b64_tr_b16 v[26:27], v244 offset:45056
    s_waitcnt lgkmcnt(14)
    v_mfma_f32_16x16x32_bf16 v[164:167], v[36:39], v[212:215], v[164:167]
    buffer_load_dwordx4 v[196:199], v2, s[44:47], s63 offen offset:1024 sc1
    v_mfma_f32_16x16x32_bf16 v[132:135], v[36:39], v[208:211], v[132:135]
    ds_read_b64_tr_b16 v[28:29], v245 offset:40960
    ds_read_b64_tr_b16 v[30:31], v245 offset:45056
    s_waitcnt lgkmcnt(14)
    v_mfma_f32_16x16x32_bf16 v[136:139], v[40:43], v[208:211], v[136:139]
    v_mfma_f32_16x16x32_bf16 v[168:171], v[40:43], v[212:215], v[168:171]
    ds_read_b64_tr_b16 v[32:33], v246 offset:40960
    ds_read_b64_tr_b16 v[34:35], v246 offset:45056
    s_waitcnt lgkmcnt(14)
    v_mfma_f32_16x16x32_bf16 v[172:175], v[44:47], v[212:215], v[172:175]
    v_mfma_f32_16x16x32_bf16 v[140:143], v[44:47], v[208:211], v[140:143]
    ds_read_b64_tr_b16 v[36:37], v247 offset:40960
    ds_read_b64_tr_b16 v[38:39], v247 offset:45056
    s_waitcnt lgkmcnt(14)
    v_mfma_f32_16x16x32_bf16 v[112:115], v[48:51], v[216:219], v[112:115]
    v_mfma_f32_16x16x32_bf16 v[144:147], v[48:51], v[220:223], v[144:147]
    ds_read_b64_tr_b16 v[40:41], v242 offset:49152
    ds_read_b64_tr_b16 v[42:43], v242 offset:53248
    s_add_u32 m0, s91, 24576
    s_add_u32 s62, s87, 1376256
    buffer_load_dwordx4 v13, s[36:39], s62 offen lds
    s_waitcnt lgkmcnt(14)
    v_mfma_f32_16x16x32_bf16 v[148:151], v[52:55], v[220:223], v[148:151]
    v_mfma_f32_16x16x32_bf16 v[116:119], v[52:55], v[216:219], v[116:119]
    ds_read_b64_tr_b16 v[44:45], v243 offset:49152
    ds_read_b64_tr_b16 v[46:47], v243 offset:53248
    s_waitcnt lgkmcnt(14)
    v_mfma_f32_16x16x32_bf16 v[120:123], v[16:19], v[216:219], v[120:123]
    s_add_u32 m0, s91, 4294942720
    s_add_u32 s62, s88, 458752
    buffer_load_dwordx4 v13, s[76:79], s62 offen lds
    v_mfma_f32_16x16x32_bf16 v[152:155], v[16:19], v[220:223], v[152:155]
    ds_read_b64_tr_b16 v[48:49], v244 offset:49152
    ds_read_b64_tr_b16 v[50:51], v244 offset:53248
    s_waitcnt lgkmcnt(14)
    v_mfma_f32_16x16x32_bf16 v[156:159], v[20:23], v[220:223], v[156:159]
    v_mfma_f32_16x16x32_bf16 v[124:127], v[20:23], v[216:219], v[124:127]
    ds_read_b64_tr_b16 v[52:53], v245 offset:49152
    ds_read_b64_tr_b16 v[54:55], v245 offset:53248
    s_add_u32 s63, s90, 24576
    buffer_load_dwordx4 v[200:203], v2, s[44:47], s63 offen sc1
    s_waitcnt lgkmcnt(14)
    v_mfma_f32_16x16x32_bf16 v[128:131], v[24:27], v[216:219], v[128:131]
    v_mfma_f32_16x16x32_bf16 v[160:163], v[24:27], v[220:223], v[160:163]
    ds_read_b64_tr_b16 v[16:17], v246 offset:49152
    ds_read_b64_tr_b16 v[18:19], v246 offset:53248
    s_waitcnt lgkmcnt(14)
    v_mfma_f32_16x16x32_bf16 v[164:167], v[28:31], v[220:223], v[164:167]
    buffer_load_dwordx4 v[204:207], v2, s[44:47], s63 offen offset:1024 sc1
    v_mfma_f32_16x16x32_bf16 v[132:135], v[28:31], v[216:219], v[132:135]
    ds_read_b64_tr_b16 v[20:21], v247 offset:49152
    ds_read_b64_tr_b16 v[22:23], v247 offset:53248
    s_waitcnt lgkmcnt(14)
    v_mfma_f32_16x16x32_bf16 v[136:139], v[32:35], v[216:219], v[136:139]
    v_mfma_f32_16x16x32_bf16 v[168:171], v[32:35], v[220:223], v[168:171]
    s_waitcnt lgkmcnt(12)
    v_mfma_f32_16x16x32_bf16 v[172:175], v[36:39], v[220:223], v[172:175]
    v_mfma_f32_16x16x32_bf16 v[140:143], v[36:39], v[216:219], v[140:143]
    s_cmp_eq_u32 s20, 5
    s_cbranch_scc0 L2_p21_ok
    s_waitcnt vmcnt(8)
    s_mov_b32 s69, 0x40000
L2_p21:
    v_cmp_gt_u32 vcc, 4, v254
    s_cbranch_vccz L2_p21_go
    s_sub_u32 s69, s69, 1
    s_cbranch_scc1 L2_p21_go
    buffer_load_dword v254, v252, s[44:47], 0 offen sc1
    s_waitcnt vmcnt(0)
    s_branch L2_p21
L2_p21_go:
    s_cmp_lg_u32 s83, 0
    s_cbranch_scc1 L2_p21_ok
    buffer_inv sc1
    s_waitcnt vmcnt(0)
L2_p21_ok:
    s_waitcnt vmcnt(15)
    s_barrier
    s_waitcnt lgkmcnt(10)
    v_mfma_f32_16x16x32_bf16 v[120:123], v[40:43], v[224:227], v[120:123]
    ds_read_b64_tr_b16 v[24:25], v242 offset:57344
    ds_read_b64_tr_b16 v[26:27], v242 offset:61440
    ds_read_b64_tr_b16 v[28:29], v243 offset:57344
    ds_read_b64_tr_b16 v[30:31], v243 offset:61440
    buffer_load_dwordx4 v[104:107], v15, s[44:47], s13 offen offset:0 sc1
    buffer_load_dwordx4 v[108:111], v15, s[44:47], s13 offen offset:256 sc1
    v_mfma_f32_16x16x32_bf16 v[152:155], v[40:43], v[228:231], v[152:155]
    ds_read_b64_tr_b16 v[32:33], v244 offset:57344
    ds_read_b64_tr_b16 v[34:35], v244 offset:61440
    s_add_u32 m0, s91, 32768
    s_add_u32 s62, s88, 0
    buffer_load_dwordx4 v13, s[76:79], s62 offen lds
    s_waitcnt lgkmcnt(14)
    v_mfma_f32_16x16x32_bf16 v[156:159], v[44:47], v[228:231], v[156:159]
    v_mfma_f32_16x16x32_bf16 v[124:127], v[44:47], v[224:227], v[124:127]
    ds_read_b64_tr_b16 v[36:37], v245 offset:57344
    ds_read_b64_tr_b16 v[38:39], v245 offset:61440
    s_add_u32 s63, s92, 0
    buffer_load_dwordx4 v[208:211], v2, s[44:47], s63 offen sc1
    s_waitcnt lgkmcnt(14)
    v_mfma_f32_16x16x32_bf16 v[128:131], v[48:51], v[224:227], v[128:131]
    v_mfma_f32_16x16x32_bf16 v[160:163], v[48:51], v[228:231], v[160:163]
    ds_read_b64_tr_b16 v[40:41], v246 offset:57344
    ds_read_b64_tr_b16 v[42:43], v246 offset:61440
    buffer_load_dwordx4 v[212:215], v2, s[44:47], s63 offen offset:1024 sc1
    s_waitcnt lgkmcnt(14)
    v_mfma_f32_16x16x32_bf16 v[164:167], v[52:55], v[228:231], v[164:167]
    v_mfma_f32_16x16x32_bf16 v[132:135], v[52:55], v[224:227], v[132:135]
    ds_read_b64_tr_b16 v[44:45], v247 offset:57344
    ds_read_b64_tr_b16 v[46:47], v247 offset:61440
    s_add_u32 s63, s92, 8192
    buffer_load_dwordx4 v[216:219], v2, s[44:47], s63 offen sc1
    s_waitcnt lgkmcnt(14)
    v_mfma_f32_16x16x32_bf16 v[136:139], v[16:19], v[224:227], v[136:139]
    v_mfma_f32_16x16x32_bf16 v[168:171], v[16:19], v[228:231], v[168:171]
    ds_read_b64_tr_b16 v[48:49], v242 offset:0
    ds_read_b64_tr_b16 v[50:51], v242 offset:4096
    buffer_load_dwordx4 v[220:223], v2, s[44:47], s63 offen offset:1024 sc1
    s_waitcnt lgkmcnt(14)
    v_mfma_f32_16x16x32_bf16 v[172:175], v[20:23], v[228:231], v[172:175]
    v_mfma_f32_16x16x32_bf16 v[140:143], v[20:23], v[224:227], v[140:143]
    ds_read_b64_tr_b16 v[52:53], v243 offset:0
    ds_read_b64_tr_b16 v[54:55], v243 offset:4096
    s_waitcnt lgkmcnt(14)
    v_mfma_f32_16x16x32_bf16 v[120:123], v[24:27], v[232:235], v[120:123]
    v_mfma_f32_16x16x32_bf16 v[152:155], v[24:27], v[236:239], v[152:155]
    ds_read_b64_tr_b16 v[16:17], v244 offset:0
    ds_read_b64_tr_b16 v[18:19], v244 offset:4096
    s_add_u32 m0, s91, 40960
    s_add_u32 s62, s88, 65536
    buffer_load_dwordx4 v13, s[76:79], s62 offen lds
    s_waitcnt lgkmcnt(14)
    v_mfma_f32_16x16x32_bf16 v[156:159], v[28:31], v[236:239], v[156:159]
    v_mfma_f32_16x16x32_bf16 v[124:127], v[28:31], v[232:235], v[124:127]
    ds_read_b64_tr_b16 v[20:21], v245 offset:0
    ds_read_b64_tr_b16 v[22:23], v245 offset:4096
    s_add_u32 s63, s92, 16384
    buffer_load_dwordx4 v[56:59], v2, s[44:47], s63 offen sc1
    s_waitcnt lgkmcnt(14)
    v_mfma_f32_16x16x32_bf16 v[128:131], v[32:35], v[232:235], v[128:131]
    v_mfma_f32_16x16x32_bf16 v[160:163], v[32:35], v[236:239], v[160:163]
    ds_read_b64_tr_b16 v[24:25], v246 offset:0
    ds_read_b64_tr_b16 v[26:27], v246 offset:4096
    buffer_load_dwordx4 v[60:63], v2, s[44:47], s63 offen offset:1024 sc1
    s_waitcnt lgkmcnt(14)
    v_mfma_f32_16x16x32_bf16 v[164:167], v[36:39], v[236:239], v[164:167]
    v_mfma_f32_16x16x32_bf16 v[132:135], v[36:39], v[232:235], v[132:135]
    ds_read_b64_tr_b16 v[28:29], v247 offset:0
    ds_read_b64_tr_b16 v[30:31], v247 offset:4096
    s_add_u32 s63, s92, 24576
    buffer_load_dwordx4 v[64:67], v2, s[44:47], s63 offen sc1
    s_waitcnt lgkmcnt(14)
    v_mfma_f32_16x16x32_bf16 v[136:139], v[40:43], v[232:235], v[136:139]
    v_mfma_f32_16x16x32_bf16 v[168:171], v[40:43], v[236:239], v[168:171]
    buffer_load_dwordx4 v[68:71], v2, s[44:47], s63 offen offset:1024 sc1
    s_waitcnt lgkmcnt(12)
    v_mfma_f32_16x16x32_bf16 v[172:175], v[44:47], v[236:239], v[172:175]
    v_mfma_f32_16x16x32_bf16 v[140:143], v[44:47], v[232:235], v[140:143]
    s_waitcnt vmcnt(19)
    s_barrier
    s_waitcnt lgkmcnt(10)
    v_mfma_f32_16x16x32_bf16 v[120:123], v[48:51], v[176:179], v[120:123]
    ds_read_b64_tr_b16 v[32:33], v242 offset:8192
    ds_read_b64_tr_b16 v[34:35], v242 offset:12288
    ds_read_b64_tr_b16 v[36:37], v243 offset:8192
    ds_read_b64_tr_b16 v[38:39], v243 offset:12288
    s_mul_i32 s66, s84, 49152
    s_sub_u32 s66, s25, s66
    v_mfma_f32_16x16x32_bf16 v[152:155], v[48:51], v[180:183], v[152:155]
    ds_read_b64_tr_b16 v[40:41], v244 offset:8192
    ds_read_b64_tr_b16 v[42:43], v244 offset:12288
    s_add_u32 s63, s92, 32768
    buffer_load_dwordx4 v[72:75], v2, s[44:47], s63 offen sc1
    s_sub_u32 s67, s84, 1
    s_and_b32 s67, s67, 3
    s_waitcnt lgkmcnt(14)
    v_mfma_f32_16x16x32_bf16 v[156:159], v[52:55], v[180:183], v[156:159]
    s_mul_i32 s67, s67, 49152
    s_add_u32 s67, s67, 0
    v_mfma_f32_16x16x32_bf16 v[124:127], v[52:55], v[176:179], v[124:127]
    ds_read_b64_tr_b16 v[44:45], v245 offset:8192
    ds_read_b64_tr_b16 v[46:47], v245 offset:12288
    buffer_load_dwordx4 v[76:79], v2, s[44:47], s63 offen offset:1024 sc1
    s_add_u32 s33, s66, s67
    s_sub_u32 s67, s84, 2
    s_waitcnt lgkmcnt(14)
    v_mfma_f32_16x16x32_bf16 v[128:131], v[16:19], v[176:179], v[128:131]
    s_and_b32 s67, s67, 3
    s_mul_i32 s67, s67, 49152
    v_mfma_f32_16x16x32_bf16 v[160:163], v[16:19], v[180:183], v[160:163]
    ds_read_b64_tr_b16 v[48:49], v246 offset:8192
    ds_read_b64_tr_b16 v[50:51], v246 offset:12288
    s_add_u32 s67, s67, 16384
    s_add_u32 s34, s66, s67
    s_waitcnt lgkmcnt(14)
    v_mfma_f32_16x16x32_bf16 v[164:167], v[20:23], v[180:183], v[164:167]
    s_add_u32 s63, s92, 40960
    buffer_load_dwordx4 v[80:83], v2, s[44:47], s63 offen sc1
    s_sub_u32 s67, s84, 3
    s_and_b32 s67, s67, 3
    v_mfma_f32_16x16x32_bf16 v[132:135], v[20:23], v[176:179], v[132:135]
    ds_read_b64_tr_b16 v[52:53], v247 offset:8192
    ds_read_b64_tr_b16 v[54:55], v247 offset:12288
    s_mul_i32 s67, s67, 49152
    s_add_u32 s67, s67, 32768
    s_waitcnt lgkmcnt(14)
    v_mfma_f32_16x16x32_bf16 v[136:139], v[24:27], v[176:179], v[136:139]
    buffer_load_dwordx4 v[84:87], v2, s[44:47], s63 offen offset:1024 sc1
    s_add_u32 s35, s66, s67
    s_lshl_b32 s14, s23, 19
    v_mfma_f32_16x16x32_bf16 v[168:171], v[24:27], v[180:183], v[168:171]
    ds_read_b64_tr_b16 v[16:17], v242 offset:16384
    ds_read_b64_tr_b16 v[18:19], v242 offset:20480
    s_lshl_b32 s67, s20, 16
    s_add_u32 s14, s14, s67
    s_waitcnt lgkmcnt(14)
    v_mfma_f32_16x16x32_bf16 v[172:175], v[28:31], v[180:183], v[172:175]
    s_lshl_b32 s67, s85, 8
    s_add_u32 s14, s14, s67
    v_mfma_f32_16x16x32_bf16 v[140:143], v[28:31], v[176:179], v[140:143]
    ds_read_b64_tr_b16 v[20:21], v243 offset:16384
    ds_read_b64_tr_b16 v[22:23], v243 offset:20480
    s_lshl_b32 s67, s84, 6
    s_add_u32 s14, s14, s67
    s_waitcnt lgkmcnt(14)
    v_mfma_f32_16x16x32_bf16 v[120:123], v[32:35], v[184:187], v[120:123]
    s_add_u32 s15, s14, 32768
    s_mov_b32 s32, 0
    v_mfma_f32_16x16x32_bf16 v[152:155], v[32:35], v[188:191], v[152:155]
    ds_read_b64_tr_b16 v[24:25], v244 offset:16384
    ds_read_b64_tr_b16 v[26:27], v244 offset:20480
    s_add_u32 s63, s92, 49152
    buffer_load_dwordx4 v[88:91], v2, s[44:47], s63 offen sc1
    s_andn2_b32 s68, s95, 0xc0
    v_mov_b32 v6, 1
    s_waitcnt lgkmcnt(14)
    v_mfma_f32_16x16x32_bf16 v[156:159], v[36:39], v[188:191], v[156:159]
    v_and_b32 v5, 3, v1
    v_cmp_ne_u32 s[70:71], s84, v5
    v_mfma_f32_16x16x32_bf16 v[124:127], v[36:39], v[184:187], v[124:127]
    ds_read_b64_tr_b16 v[28:29], v245 offset:16384
    ds_read_b64_tr_b16 v[30:31], v245 offset:20480
    buffer_load_dwordx4 v[92:95], v2, s[44:47], s63 offen offset:1024 sc1
    v_lshlrev_b32 v5, 6, v5
    v_and_b32 v4, 15, v1
    s_waitcnt lgkmcnt(14)
    v_mfma_f32_16x16x32_bf16 v[128:131], v[40:43], v[184:187], v[128:131]
    v_lshlrev_b32 v4, 11, v4
    v_bfe_u32 v7, v1, 4, 1
    v_mfma_f32_16x16x32_bf16 v[160:163], v[40:43], v[188:191], v[160:163]
    ds_read_b64_tr_b16 v[32:33], v246 offset:16384
    ds_read_b64_tr_b16 v[34:35], v246 offset:20480
    v_lshl_add_u32 v4, v7, 5, v4
    v_lshrrev_b32 v7, 5, v1
    s_waitcnt lgkmcnt(14)
    v_mfma_f32_16x16x32_bf16 v[164:167], v[44:47], v[188:191], v[164:167]
    s_add_u32 s63, s92, 57344
    buffer_load_dwordx4 v[96:99], v2, s[44:47], s63 offen sc1
    v_lshl_add_u32 v4, v7, 4, v4
    v_mfma_f32_16x16x32_bf16 v[132:135], v[44:47], v[184:187], v[132:135]
    ds_read_b64_tr_b16 v[36:37], v247 offset:16384
    ds_read_b64_tr_b16 v[38:39], v247 offset:20480
    s_waitcnt lgkmcnt(14)
    v_mfma_f32_16x16x32_bf16 v[136:139], v[48:51], v[184:187], v[136:139]
    buffer_load_dwordx4 v[100:103], v2, s[44:47], s63 offen offset:1024 sc1
    v_mfma_f32_16x16x32_bf16 v[168:171], v[48:51], v[188:191], v[168:171]
    s_waitcnt lgkmcnt(12)
    v_mfma_f32_16x16x32_bf16 v[172:175], v[52:55], v[188:191], v[172:175]
    v_mfma_f32_16x16x32_bf16 v[140:143], v[52:55], v[184:187], v[140:143]
    s_waitcnt vmcnt(17)
    s_barrier
    s_waitcnt lgkmcnt(10)
    v_mfma_f32_16x16x32_bf16 v[120:123], v[16:19], v[192:195], v[120:123]
    ds_read_b64_tr_b16 v[40:41], v242 offset:24576
    ds_read_b64_tr_b16 v[42:43], v242 offset:28672
    ds_read_b64_tr_b16 v[44:45], v243 offset:24576
    ds_read_b64_tr_b16 v[46:47], v243 offset:28672
    v_mfma_f32_16x16x32_bf16 v[152:155], v[16:19], v[196:199], v[152:155]
    ds_read_b64_tr_b16 v[48:49], v244 offset:24576
    ds_read_b64_tr_b16 v[50:51], v244 offset:28672
    s_waitcnt lgkmcnt(14)
    v_mfma_f32_16x16x32_bf16 v[156:159], v[20:23], v[196:199], v[156:159]
    v_mfma_f32_16x16x32_bf16 v[124:127], v[20:23], v[192:195], v[124:127]
    ds_read_b64_tr_b16 v[52:53], v245 offset:24576
    ds_read_b64_tr_b16 v[54:55], v245 offset:28672
    s_waitcnt lgkmcnt(14)
    v_mfma_f32_16x16x32_bf16 v[128:131], v[24:27], v[192:195], v[128:131]
    v_mfma_f32_16x16x32_bf16 v[160:163], v[24:27], v[196:199], v[160:163]
    ds_read_b64_tr_b16 v[16:17], v246 offset:24576
    ds_read_b64_tr_b16 v[18:19], v246 offset:28672
    s_waitcnt lgkmcnt(14)
    v_mfma_f32_16x16x32_bf16 v[164:167], v[28:31], v[196:199], v[164:167]
    v_mfma_f32_16x16x32_bf16 v[132:135], v[28:31], v[192:195], v[132:135]
    ds_read_b64_tr_b16 v[20:21], v247 offset:24576
    ds_read_b64_tr_b16 v[22:23], v247 offset:28672
    s_waitcnt lgkmcnt(14)
    v_mfma_f32_16x16x32_bf16 v[136:139], v[32:35], v[192:195], v[136:139]
    v_mfma_f32_16x16x32_bf16 v[168:171], v[32:35], v[196:199], v[168:171]
    ds_read_b64_tr_b16 v[24:25], v242 offset:32768
    ds_read_b64_tr_b16 v[26:27], v242 offset:36864
    s_waitcnt lgkmcnt(14)
    v_mfma_f32_16x16x32_bf16 v[172:175], v[36:39], v[196:199], v[172:175]
    v_mfma_f32_16x16x32_bf16 v[140:143], v[36:39], v[192:195], v[140:143]
    ds_read_b64_tr_b16 v[28:29], v243 offset:32768
    ds_read_b64_tr_b16 v[30:31], v243 offset:36864
    s_waitcnt lgkmcnt(14)
    v_mfma_f32_16x16x32_bf16 v[120:123], v[40:43], v[200:203], v[120:123]
    v_mfma_f32_16x16x32_bf16 v[152:155], v[40:43], v[204:207], v[152:155]
    ds_read_b64_tr_b16 v[32:33], v244 offset:32768
    ds_read_b64_tr_b16 v[34:35], v244 offset:36864
    s_waitcnt lgkmcnt(14)
    v_mfma_f32_16x16x32_bf16 v[156:159], v[44:47], v[204:207], v[156:159]
    v_mfma_f32_16x16x32_bf16 v[124:127], v[44:47], v[200:203], v[124:127]
    ds_read_b64_tr_b16 v[36:37], v245 offset:32768
    ds_read_b64_tr_b16 v[38:39], v245 offset:36864
    s_waitcnt lgkmcnt(14)
    v_mfma_f32_16x16x32_bf16 v[128:131], v[48:51], v[200:203], v[128:131]
    v_mfma_f32_16x16x32_bf16 v[160:163], v[48:51], v[204:207], v[160:163]
    ds_read_b64_tr_b16 v[40:41], v246 offset:32768
    ds_read_b64_tr_b16 v[42:43], v246 offset:36864
    v_mul_f32 v120, v120, v104
    v_mul_f32 v121, v121, v105
    s_waitcnt lgkmcnt(14)
    v_mfma_f32_16x16x32_bf16 v[164:167], v[52:55], v[204:207], v[164:167]
    v_mul_f32 v122, v122, v104
    v_mul_f32 v123, v123, v105
    v_mul_f32 v152, v152, v108
    v_mul_f32 v153, v153, v109
    v_mfma_f32_16x16x32_bf16 v[132:135], v[52:55], v[200:203], v[132:135]
    ds_read_b64_tr_b16 v[44:45], v247 offset:32768
    ds_read_b64_tr_b16 v[46:47], v247 offset:36864
    v_mul_f32 v154, v154, v108
    v_mul_f32 v155, v155, v109
    v_mul_f32 v156, v156, v108
    v_mul_f32 v157, v157, v109
    s_waitcnt lgkmcnt(14)
    v_mfma_f32_16x16x32_bf16 v[136:139], v[16:19], v[200:203], v[136:139]
    v_mul_f32 v124, v124, v104
    v_mul_f32 v125, v125, v105
    v_mul_f32 v158, v158, v108
    v_mul_f32 v159, v159, v109
    v_mfma_f32_16x16x32_bf16 v[168:171], v[16:19], v[204:207], v[168:171]
    v_mul_f32 v126, v126, v104
    v_mul_f32 v127, v127, v105
    v_mul_f32 v128, v128, v104
    v_mul_f32 v129, v129, v105
    s_waitcnt lgkmcnt(12)
    v_mfma_f32_16x16x32_bf16 v[172:175], v[20:23], v[204:207], v[172:175]
    v_mul_f32 v130, v130, v104
    v_mul_f32 v131, v131, v105
    v_mul_f32 v160, v160, v108
    v_mul_f32 v161, v161, v109
    v_mfma_f32_16x16x32_bf16 v[140:143], v[20:23], v[200:203], v[140:143]
    v_mul_f32 v162, v162, v108
    v_mul_f32 v163, v163, v109
    v_mul_f32 v164, v164, v108
    v_mul_f32 v165, v165, v109
    s_waitcnt vmcnt(12)
    s_barrier
    s_waitcnt lgkmcnt(10)
    v_mfma_f32_16x16x32_bf16 v[120:123], v[24:27], v[208:211], v[120:123]
    ds_read_b64_tr_b16 v[48:49], v242 offset:40960
    ds_read_b64_tr_b16 v[50:51], v242 offset:45056
    ds_read_b64_tr_b16 v[52:53], v243 offset:40960
    ds_read_b64_tr_b16 v[54:55], v243 offset:45056
    v_mul_f32 v132, v132, v104
    v_mul_f32 v133, v133, v105
    v_mul_f32 v166, v166, v108
    v_mul_f32 v167, v167, v109
    v_mfma_f32_16x16x32_bf16 v[152:155], v[24:27], v[212:215], v[152:155]
    ds_read_b64_tr_b16 v[16:17], v244 offset:40960
    ds_read_b64_tr_b16 v[18:19], v244 offset:45056
    v_mul_f32 v134, v134, v104
    v_mul_f32 v135, v135, v105
    v_mul_f32 v136, v136, v104
    v_mul_f32 v137, v137, v105
    s_waitcnt lgkmcnt(14)
    v_mfma_f32_16x16x32_bf16 v[156:159], v[28:31], v[212:215], v[156:159]
    v_mul_f32 v138, v138, v104
    v_mul_f32 v139, v139, v105
    v_mul_f32 v168, v168, v108
    v_mul_f32 v169, v169, v109
    v_mfma_f32_16x16x32_bf16 v[124:127], v[28:31], v[208:211], v[124:127]
    ds_read_b64_tr_b16 v[20:21], v245 offset:40960
    ds_read_b64_tr_b16 v[22:23], v245 offset:45056
    v_mul_f32 v170, v170, v108
    v_mul_f32 v171, v171, v109
    v_mul_f32 v172, v172, v108
    v_mul_f32 v173, v173, v109
    s_waitcnt lgkmcnt(14)
    v_mfma_f32_16x16x32_bf16 v[128:131], v[32:35], v[208:211], v[128:131]
    v_mul_f32 v140, v140, v104
    v_mul_f32 v141, v141, v105
    v_mul_f32 v174, v174, v108
    v_mul_f32 v175, v175, v109
    v_mfma_f32_16x16x32_bf16 v[160:163], v[32:35], v[212:215], v[160:163]
    ds_read_b64_tr_b16 v[24:25], v246 offset:40960
    ds_read_b64_tr_b16 v[26:27], v246 offset:45056
    v_mul_f32 v142, v142, v104
    v_mul_f32 v143, v143, v105
    s_waitcnt lgkmcnt(14)
    v_mfma_f32_16x16x32_bf16 v[164:167], v[36:39], v[212:215], v[164:167]
    v_mfma_f32_16x16x32_bf16 v[132:135], v[36:39], v[208:211], v[132:135]
    ds_read_b64_tr_b16 v[28:29], v247 offset:40960
    ds_read_b64_tr_b16 v[30:31], v247 offset:45056
    s_waitcnt lgkmcnt(14)
    v_mfma_f32_16x16x32_bf16 v[136:139], v[40:43], v[208:211], v[136:139]
    v_mfma_f32_16x16x32_bf16 v[168:171], v[40:43], v[212:215], v[168:171]
    v_add_u32 v242, 4294901760, v242
    ds_read_b64_tr_b16 v[32:33], v242 offset:0
    ds_read_b64_tr_b16 v[34:35], v242 offset:4096
    s_waitcnt lgkmcnt(14)
    v_mfma_f32_16x16x32_bf16 v[172:175], v[44:47], v[212:215], v[172:175]
    v_mfma_f32_16x16x32_bf16 v[140:143], v[44:47], v[208:211], v[140:143]
    v_add_u32 v243, 4294901760, v243
    ds_read_b64_tr_b16 v[36:37], v243 offset:0
    ds_read_b64_tr_b16 v[38:39], v243 offset:4096
    s_waitcnt lgkmcnt(14)
    v_mfma_f32_16x16x32_bf16 v[120:123], v[48:51], v[216:219], v[120:123]
    v_mfma_f32_16x16x32_bf16 v[152:155], v[48:51], v[220:223], v[152:155]
    ds_read_b64_tr_b16 v[40:41], v242 offset:8192
    ds_read_b64_tr_b16 v[42:43], v242 offset:12288
    s_waitcnt lgkmcnt(14)
    v_mfma_f32_16x16x32_bf16 v[156:159], v[52:55], v[220:223], v[156:159]
    v_mfma_f32_16x16x32_bf16 v[124:127], v[52:55], v[216:219], v[124:127]
    ds_read_b64_tr_b16 v[44:45], v243 offset:8192
    ds_read_b64_tr_b16 v[46:47], v243 offset:12288
    s_waitcnt lgkmcnt(14)
    v_mfma_f32_16x16x32_bf16 v[128:131], v[16:19], v[216:219], v[128:131]
    v_mfma_f32_16x16x32_bf16 v[160:163], v[16:19], v[220:223], v[160:163]
    ds_read_b64_tr_b16 v[48:49], v242 offset:16384
    ds_read_b64_tr_b16 v[50:51], v242 offset:20480
    s_waitcnt lgkmcnt(14)
    v_mfma_f32_16x16x32_bf16 v[164:167], v[20:23], v[220:223], v[164:167]
    v_mfma_f32_16x16x32_bf16 v[132:135], v[20:23], v[216:219], v[132:135]
    ds_read_b64_tr_b16 v[52:53], v243 offset:16384
    ds_read_b64_tr_b16 v[54:55], v243 offset:20480
    s_waitcnt lgkmcnt(14)
    v_mfma_f32_16x16x32_bf16 v[136:139], v[24:27], v[216:219], v[136:139]
    v_mfma_f32_16x16x32_bf16 v[168:171], v[24:27], v[220:223], v[168:171]
    ds_read_b64_tr_b16 v[16:17], v242 offset:24576
    ds_read_b64_tr_b16 v[18:19], v242 offset:28672
    s_waitcnt lgkmcnt(14)
    v_mfma_f32_16x16x32_bf16 v[172:175], v[28:31], v[220:223], v[172:175]
    v_mfma_f32_16x16x32_bf16 v[140:143], v[28:31], v[216:219], v[140:143]
    ds_read_b64_tr_b16 v[20:21], v243 offset:24576
    ds_read_b64_tr_b16 v[22:23], v243 offset:28672
    s_waitcnt vmcnt(11)
    s_waitcnt lgkmcnt(14)
    v_mfma_f32_16x16x32_bf16 v[120:123], v[32:35], v[56:59], v[120:123]
    s_waitcnt vmcnt(10)
    v_mfma_f32_16x16x32_bf16 v[152:155], v[32:35], v[60:63], v[152:155]
    ds_read_b64_tr_b16 v[24:25], v242 offset:32768
    ds_read_b64_tr_b16 v[26:27], v242 offset:36864
    s_waitcnt lgkmcnt(14)
    v_mfma_f32_16x16x32_bf16 v[156:159], v[36:39], v[60:63], v[156:159]
    v_mfma_f32_16x16x32_bf16 v[124:127], v[36:39], v[56:59], v[124:127]
    ds_read_b64_tr_b16 v[28:29], v243 offset:32768
    ds_read_b64_tr_b16 v[30:31], v243 offset:36864
    s_waitcnt vmcnt(9)
    s_waitcnt lgkmcnt(14)
    v_mfma_f32_16x16x32_bf16 v[120:123], v[40:43], v[64:67], v[120:123]
    s_waitcnt vmcnt(8)
    v_mfma_f32_16x16x32_bf16 v[152:155], v[40:43], v[68:71], v[152:155]
    ds_read_b64_tr_b16 v[32:33], v242 offset:40960
    ds_read_b64_tr_b16 v[34:35], v242 offset:45056
    s_waitcnt lgkmcnt(14)
    v_mfma_f32_16x16x32_bf16 v[156:159], v[44:47], v[68:71], v[156:159]
    v_mfma_f32_16x16x32_bf16 v[124:127], v[44:47], v[64:67], v[124:127]
    ds_read_b64_tr_b16 v[36:37], v243 offset:40960
    ds_read_b64_tr_b16 v[38:39], v243 offset:45056
    s_waitcnt vmcnt(7)
    s_waitcnt lgkmcnt(14)
    v_mfma_f32_16x16x32_bf16 v[120:123], v[48:51], v[72:75], v[120:123]
    s_waitcnt vmcnt(6)
    v_mfma_f32_16x16x32_bf16 v[152:155], v[48:51], v[76:79], v[152:155]
    v_add_u32 v244, 4294901760, v244
    ds_read_b64_tr_b16 v[40:41], v244 offset:0
    ds_read_b64_tr_b16 v[42:43], v244 offset:4096
    s_waitcnt lgkmcnt(14)
    v_mfma_f32_16x16x32_bf16 v[156:159], v[52:55], v[76:79], v[156:159]
    v_mfma_f32_16x16x32_bf16 v[124:127], v[52:55], v[72:75], v[124:127]
    v_add_u32 v245, 4294901760, v245
    ds_read_b64_tr_b16 v[44:45], v245 offset:0
    ds_read_b64_tr_b16 v[46:47], v245 offset:4096
    s_waitcnt vmcnt(5)
    s_waitcnt lgkmcnt(14)
    v_mfma_f32_16x16x32_bf16 v[120:123], v[16:19], v[80:83], v[120:123]
    s_waitcnt vmcnt(4)
    v_mfma_f32_16x16x32_bf16 v[152:155], v[16:19], v[84:87], v[152:155]
    ds_read_b64_tr_b16 v[48:49], v244 offset:8192
    ds_read_b64_tr_b16 v[50:51], v244 offset:12288
    s_waitcnt lgkmcnt(14)
    v_mfma_f32_16x16x32_bf16 v[156:159], v[20:23], v[84:87], v[156:159]
    v_mfma_f32_16x16x32_bf16 v[124:127], v[20:23], v[80:83], v[124:127]
    ds_read_b64_tr_b16 v[52:53], v245 offset:8192
    ds_read_b64_tr_b16 v[54:55], v245 offset:12288
    s_waitcnt vmcnt(3)
    s_waitcnt lgkmcnt(14)
    v_mfma_f32_16x16x32_bf16 v[120:123], v[24:27], v[88:91], v[120:123]
    s_waitcnt vmcnt(2)
    v_mfma_f32_16x16x32_bf16 v[152:155], v[24:27], v[92:95], v[152:155]
    ds_read_b64_tr_b16 v[16:17], v244 offset:16384
    ds_read_b64_tr_b16 v[18:19], v244 offset:20480
    s_waitcnt lgkmcnt(14)
    v_mfma_f32_16x16x32_bf16 v[156:159], v[28:31], v[92:95], v[156:159]
    v_mfma_f32_16x16x32_bf16 v[124:127], v[28:31], v[88:91], v[124:127]
    ds_read_b64_tr_b16 v[20:21], v245 offset:16384
    ds_read_b64_tr_b16 v[22:23], v245 offset:20480
    s_waitcnt vmcnt(1)
    s_waitcnt lgkmcnt(14)
    v_mfma_f32_16x16x32_bf16 v[120:123], v[32:35], v[96:99], v[120:123]
    s_waitcnt vmcnt(0)
    v_mfma_f32_16x16x32_bf16 v[152:155], v[32:35], v[100:103], v[152:155]
    ds_read_b64_tr_b16 v[24:25], v244 offset:24576
    ds_read_b64_tr_b16 v[26:27], v244 offset:28672
    s_waitcnt lgkmcnt(14)
    v_mfma_f32_16x16x32_bf16 v[156:159], v[36:39], v[100:103], v[156:159]
    v_mfma_f32_16x16x32_bf16 v[124:127], v[36:39], v[96:99], v[124:127]
    ds_read_b64_tr_b16 v[28:29], v245 offset:24576
    ds_read_b64_tr_b16 v[30:31], v245 offset:28672
    s_waitcnt lgkmcnt(14)
    v_mfma_f32_16x16x32_bf16 v[128:131], v[40:43], v[56:59], v[128:131]
    v_mfma_f32_16x16x32_bf16 v[160:163], v[40:43], v[60:63], v[160:163]
    ds_read_b64_tr_b16 v[32:33], v244 offset:32768
    ds_read_b64_tr_b16 v[34:35], v244 offset:36864
    s_waitcnt lgkmcnt(14)
    v_mfma_f32_16x16x32_bf16 v[164:167], v[44:47], v[60:63], v[164:167]
    v_mfma_f32_16x16x32_bf16 v[132:135], v[44:47], v[56:59], v[132:135]
    ds_read_b64_tr_b16 v[36:37], v245 offset:32768
    ds_read_b64_tr_b16 v[38:39], v245 offset:36864
    v_mul_f32 v120, v120, v106
    v_mul_f32 v121, v121, v107
    v_mul_f32 v122, v122, v106
    v_mul_f32 v123, v123, v107
    s_waitcnt lgkmcnt(14)
    v_mfma_f32_16x16x32_bf16 v[128:131], v[48:51], v[64:67], v[128:131]
    v_mul_f32 v124, v124, v106
    v_mul_f32 v125, v125, v107
    v_mfma_f32_16x16x32_bf16 v[160:163], v[48:51], v[68:71], v[160:163]
    ds_read_b64_tr_b16 v[40:41], v244 offset:40960
    ds_read_b64_tr_b16 v[42:43], v244 offset:45056
    v_mul_f32 v126, v126, v106
    v_mul_f32 v127, v127, v107
    v_mul_f32 v152, v152, v110
    v_mul_f32 v153, v153, v111
    s_waitcnt lgkmcnt(14)
    v_mfma_f32_16x16x32_bf16 v[164:167], v[52:55], v[68:71], v[164:167]
    v_mul_f32 v154, v154, v110
    v_mul_f32 v155, v155, v111
    v_mfma_f32_16x16x32_bf16 v[132:135], v[52:55], v[64:67], v[132:135]
    ds_read_b64_tr_b16 v[44:45], v245 offset:40960
    ds_read_b64_tr_b16 v[46:47], v245 offset:45056
    v_mul_f32 v156, v156, v110
    v_mul_f32 v157, v157, v111
    v_mul_f32 v158, v158, v110
    v_mul_f32 v159, v159, v111
    s_waitcnt lgkmcnt(14)
    v_mfma_f32_16x16x32_bf16 v[128:131], v[16:19], v[72:75], v[128:131]
    v_cvt_pk_bf16_f32 v120, v120, v121
    v_mfma_f32_16x16x32_bf16 v[160:163], v[16:19], v[76:79], v[160:163]
    v_add_u32 v246, 4294901760, v246
    ds_read_b64_tr_b16 v[48:49], v246 offset:0
    ds_read_b64_tr_b16 v[50:51], v246 offset:4096
    v_cvt_pk_bf16_f32 v121, v122, v123
    v_cvt_pk_bf16_f32 v122, v124, v125
    s_waitcnt lgkmcnt(14)
    v_mfma_f32_16x16x32_bf16 v[164:167], v[20:23], v[76:79], v[164:167]
    v_cvt_pk_bf16_f32 v123, v126, v127
    v_mfma_f32_16x16x32_bf16 v[132:135], v[20:23], v[72:75], v[132:135]
    v_add_u32 v247, 4294901760, v247
    ds_read_b64_tr_b16 v[52:53], v247 offset:0
    ds_read_b64_tr_b16 v[54:55], v247 offset:4096
    s_add_u32 s64, s25, 0
    buffer_store_dwordx4 v[120:123], v2, s[44:47], s64 offen sc1
    v_cvt_pk_bf16_f32 v152, v152, v153
    s_waitcnt lgkmcnt(14)
    v_mfma_f32_16x16x32_bf16 v[128:131], v[24:27], v[80:83], v[128:131]
    v_cvt_pk_bf16_f32 v153, v154, v155
    v_mfma_f32_16x16x32_bf16 v[160:163], v[24:27], v[84:87], v[160:163]
    ds_read_b64_tr_b16 v[16:17], v246 offset:8192
    ds_read_b64_tr_b16 v[18:19], v246 offset:12288
    v_cvt_pk_bf16_f32 v154, v156, v157
    v_cvt_pk_bf16_f32 v155, v158, v159
    s_waitcnt lgkmcnt(14)
    v_mfma_f32_16x16x32_bf16 v[164:167], v[28:31], v[84:87], v[164:167]
    s_add_u32 s64, s25, 1024
    buffer_store_dwordx4 v[152:155], v2, s[44:47], s64 offen sc1
    v_mfma_f32_16x16x32_bf16 v[132:135], v[28:31], v[80:83], v[132:135]
    ds_read_b64_tr_b16 v[20:21], v247 offset:8192
    ds_read_b64_tr_b16 v[22:23], v247 offset:12288
    s_waitcnt lgkmcnt(14)
    v_mfma_f32_16x16x32_bf16 v[128:131], v[32:35], v[88:91], v[128:131]
    v_mfma_f32_16x16x32_bf16 v[160:163], v[32:35], v[92:95], v[160:163]
    ds_read_b64_tr_b16 v[24:25], v246 offset:16384
    ds_read_b64_tr_b16 v[26:27], v246 offset:20480
    s_waitcnt lgkmcnt(14)
    v_mfma_f32_16x16x32_bf16 v[164:167], v[36:39], v[92:95], v[164:167]
    v_mfma_f32_16x16x32_bf16 v[132:135], v[36:39], v[88:91], v[132:135]
    ds_read_b64_tr_b16 v[28:29], v247 offset:16384
    ds_read_b64_tr_b16 v[30:31], v247 offset:20480
    s_waitcnt lgkmcnt(14)
    v_mfma_f32_16x16x32_bf16 v[128:131], v[40:43], v[96:99], v[128:131]
    v_mfma_f32_16x16x32_bf16 v[160:163], v[40:43], v[100:103], v[160:163]
    ds_read_b64_tr_b16 v[32:33], v246 offset:24576
    ds_read_b64_tr_b16 v[34:35], v246 offset:28672
    s_waitcnt lgkmcnt(14)
    v_mfma_f32_16x16x32_bf16 v[164:167], v[44:47], v[100:103], v[164:167]
    v_mfma_f32_16x16x32_bf16 v[132:135], v[44:47], v[96:99], v[132:135]
    ds_read_b64_tr_b16 v[36:37], v247 offset:24576
    ds_read_b64_tr_b16 v[38:39], v247 offset:28672
    s_waitcnt lgkmcnt(14)
    v_mfma_f32_16x16x32_bf16 v[136:139], v[48:51], v[56:59], v[136:139]
    v_mfma_f32_16x16x32_bf16 v[168:171], v[48:51], v[60:63], v[168:171]
    ds_read_b64_tr_b16 v[40:41], v246 offset:32768
    ds_read_b64_tr_b16 v[42:43], v246 offset:36864
    s_waitcnt lgkmcnt(14)
    v_mfma_f32_16x16x32_bf16 v[172:175], v[52:55], v[60:63], v[172:175]
    v_mfma_f32_16x16x32_bf16 v[140:143], v[52:55], v[56:59], v[140:143]
    ds_read_b64_tr_b16 v[44:45], v247 offset:32768
    ds_read_b64_tr_b16 v[46:47], v247 offset:36864
    v_mul_f32 v128, v128, v106
    v_mul_f32 v129, v129, v107
    v_mul_f32 v130, v130, v106
    v_mul_f32 v131, v131, v107
    s_waitcnt lgkmcnt(14)
    v_mfma_f32_16x16x32_bf16 v[136:139], v[16:19], v[64:67], v[136:139]
    v_mul_f32 v132, v132, v106
    v_mul_f32 v133, v133, v107
    v_mfma_f32_16x16x32_bf16 v[168:171], v[16:19], v[68:71], v[168:171]
    ds_read_b64_tr_b16 v[48:49], v246 offset:40960
    ds_read_b64_tr_b16 v[50:51], v246 offset:45056
    v_mul_f32 v134, v134, v106
    v_mul_f32 v135, v135, v107
    v_mul_f32 v160, v160, v110
    v_mul_f32 v161, v161, v111
    s_waitcnt lgkmcnt(14)
    v_mfma_f32_16x16x32_bf16 v[172:175], v[20:23], v[68:71], v[172:175]
    v_mul_f32 v162, v162, v110
    v_mul_f32 v163, v163, v111
    v_mfma_f32_16x16x32_bf16 v[140:143], v[20:23], v[64:67], v[140:143]
    ds_read_b64_tr_b16 v[52:53], v247 offset:40960
    ds_read_b64_tr_b16 v[54:55], v247 offset:45056
    v_mul_f32 v164, v164, v110
    v_mul_f32 v165, v165, v111
    v_mul_f32 v166, v166, v110
    v_mul_f32 v167, v167, v111
    s_waitcnt lgkmcnt(14)
    v_mfma_f32_16x16x32_bf16 v[136:139], v[24:27], v[72:75], v[136:139]
    v_cvt_pk_bf16_f32 v128, v128, v129
    v_mfma_f32_16x16x32_bf16 v[168:171], v[24:27], v[76:79], v[168:171]
    ds_read_b64_tr_b16 v[16:17], v240 offset:49152
    ds_read_b64_tr_b16 v[18:19], v240 offset:53248
    v_cvt_pk_bf16_f32 v129, v130, v131
    v_cvt_pk_bf16_f32 v130, v132, v133
    s_waitcnt lgkmcnt(14)
    v_mfma_f32_16x16x32_bf16 v[172:175], v[28:31], v[76:79], v[172:175]
    v_cvt_pk_bf16_f32 v131, v134, v135
    v_mfma_f32_16x16x32_bf16 v[140:143], v[28:31], v[72:75], v[140:143]
    ds_read_b64_tr_b16 v[20:21], v241 offset:49152
    ds_read_b64_tr_b16 v[22:23], v241 offset:53248
    s_add_u32 s64, s25, 16384
    buffer_store_dwordx4 v[128:131], v2, s[44:47], s64 offen sc1
    v_cvt_pk_bf16_f32 v160, v160, v161
    s_waitcnt lgkmcnt(14)
    v_mfma_f32_16x16x32_bf16 v[136:139], v[32:35], v[80:83], v[136:139]
    v_cvt_pk_bf16_f32 v161, v162, v163
    v_mfma_f32_16x16x32_bf16 v[168:171], v[32:35], v[84:87], v[168:171]
    ds_read_b64_tr_b16 v[24:25], v240 offset:57344
    ds_read_b64_tr_b16 v[26:27], v240 offset:61440
    v_cvt_pk_bf16_f32 v162, v164, v165
    v_cvt_pk_bf16_f32 v163, v166, v167
    s_waitcnt lgkmcnt(14)
    v_mfma_f32_16x16x32_bf16 v[172:175], v[36:39], v[84:87], v[172:175]
    s_add_u32 s64, s25, 17408
    buffer_store_dwordx4 v[160:163], v2, s[44:47], s64 offen sc1
    v_mfma_f32_16x16x32_bf16 v[140:143], v[36:39], v[80:83], v[140:143]
    ds_read_b64_tr_b16 v[28:29], v241 offset:57344
    ds_read_b64_tr_b16 v[30:31], v241 offset:61440
    s_waitcnt lgkmcnt(14)
    v_mfma_f32_16x16x32_bf16 v[136:139], v[40:43], v[88:91], v[136:139]
    v_mfma_f32_16x16x32_bf16 v[168:171], v[40:43], v[92:95], v[168:171]
    ds_read_b64_tr_b16 v[32:33], v240 offset:0
    ds_read_b64_tr_b16 v[34:35], v240 offset:4096
    s_waitcnt lgkmcnt(14)
    v_mfma_f32_16x16x32_bf16 v[172:175], v[44:47], v[92:95], v[172:175]
    v_mfma_f32_16x16x32_bf16 v[140:143], v[44:47], v[88:91], v[140:143]
    ds_read_b64_tr_b16 v[36:37], v241 offset:0
    ds_read_b64_tr_b16 v[38:39], v241 offset:4096
    s_waitcnt lgkmcnt(14)
    v_mfma_f32_16x16x32_bf16 v[136:139], v[48:51], v[96:99], v[136:139]
    v_mfma_f32_16x16x32_bf16 v[168:171], v[48:51], v[100:103], v[168:171]
    ds_read_b64_tr_b16 v[40:41], v240 offset:8192
    ds_read_b64_tr_b16 v[42:43], v240 offset:12288
    s_waitcnt lgkmcnt(14)
    v_mfma_f32_16x16x32_bf16 v[172:175], v[52:55], v[100:103], v[172:175]
    v_mfma_f32_16x16x32_bf16 v[140:143], v[52:55], v[96:99], v[140:143]
    ds_read_b64_tr_b16 v[44:45], v241 offset:8192
    ds_read_b64_tr_b16 v[46:47], v241 offset:12288
    s_waitcnt lgkmcnt(14)
    v_mfma_f32_16x16x32_bf16 v[112:115], v[16:19], v[224:227], v[112:115]
    v_mfma_f32_16x16x32_bf16 v[144:147], v[16:19], v[228:231], v[144:147]
    ds_read_b64_tr_b16 v[48:49], v240 offset:16384
    ds_read_b64_tr_b16 v[50:51], v240 offset:20480
    s_waitcnt lgkmcnt(14)
    v_mfma_f32_16x16x32_bf16 v[148:151], v[20:23], v[228:231], v[148:151]
    v_mfma_f32_16x16x32_bf16 v[116:119], v[20:23], v[224:227], v[116:119]
    ds_read_b64_tr_b16 v[52:53], v241 offset:16384
    ds_read_b64_tr_b16 v[54:55], v241 offset:20480
    v_mul_f32 v136, v136, v106
    v_mul_f32 v137, v137, v107
    v_mul_f32 v138, v138, v106
    v_mul_f32 v139, v139, v107
    s_waitcnt lgkmcnt(14)
    v_mfma_f32_16x16x32_bf16 v[112:115], v[24:27], v[232:235], v[112:115]
    v_mul_f32 v140, v140, v106
    v_mul_f32 v141, v141, v107
    v_mfma_f32_16x16x32_bf16 v[144:147], v[24:27], v[236:239], v[144:147]
    ds_read_b64_tr_b16 v[16:17], v240 offset:24576
    ds_read_b64_tr_b16 v[18:19], v240 offset:28672
    v_mul_f32 v142, v142, v106
    v_mul_f32 v143, v143, v107
    v_mul_f32 v168, v168, v110
    v_mul_f32 v169, v169, v111
    s_waitcnt lgkmcnt(14)
    v_mfma_f32_16x16x32_bf16 v[148:151], v[28:31], v[236:239], v[148:151]
    v_mul_f32 v170, v170, v110
    v_mul_f32 v171, v171, v111
    v_mfma_f32_16x16x32_bf16 v[116:119], v[28:31], v[232:235], v[116:119]
    ds_read_b64_tr_b16 v[20:21], v241 offset:24576
    ds_read_b64_tr_b16 v[22:23], v241 offset:28672
    v_mul_f32 v172, v172, v110
    v_mul_f32 v173, v173, v111
    v_mul_f32 v174, v174, v110
    v_mul_f32 v175, v175, v111
    s_waitcnt lgkmcnt(14)
    v_mfma_f32_16x16x32_bf16 v[112:115], v[32:35], v[176:179], v[112:115]
    v_cvt_pk_bf16_f32 v136, v136, v137
    v_mfma_f32_16x16x32_bf16 v[144:147], v[32:35], v[180:183], v[144:147]
    ds_read_b64_tr_b16 v[24:25], v240 offset:32768
    ds_read_b64_tr_b16 v[26:27], v240 offset:36864
    v_cvt_pk_bf16_f32 v137, v138, v139
    v_cvt_pk_bf16_f32 v138, v140, v141
    s_waitcnt lgkmcnt(14)
    v_mfma_f32_16x16x32_bf16 v[148:151], v[36:39], v[180:183], v[148:151]
    v_cvt_pk_bf16_f32 v139, v142, v143
    v_mfma_f32_16x16x32_bf16 v[116:119], v[36:39], v[176:179], v[116:119]
    ds_read_b64_tr_b16 v[28:29], v241 offset:32768
    ds_read_b64_tr_b16 v[30:31], v241 offset:36864
    s_add_u32 s64, s25, 32768
    buffer_store_dwordx4 v[136:139], v2, s[44:47], s64 offen sc1
    v_cvt_pk_bf16_f32 v168, v168, v169
    s_waitcnt lgkmcnt(14)
    v_mfma_f32_16x16x32_bf16 v[112:115], v[40:43], v[184:187], v[112:115]
    v_cvt_pk_bf16_f32 v169, v170, v171
    v_mfma_f32_16x16x32_bf16 v[144:147], v[40:43], v[188:191], v[144:147]
    ds_read_b64_tr_b16 v[32:33], v240 offset:40960
    ds_read_b64_tr_b16 v[34:35], v240 offset:45056
    v_cvt_pk_bf16_f32 v170, v172, v173
    v_cvt_pk_bf16_f32 v171, v174, v175
    s_waitcnt lgkmcnt(14)
    v_mfma_f32_16x16x32_bf16 v[148:151], v[44:47], v[188:191], v[148:151]
    s_add_u32 s64, s25, 33792
    buffer_store_dwordx4 v[168:171], v2, s[44:47], s64 offen sc1
    v_mfma_f32_16x16x32_bf16 v[116:119], v[44:47], v[184:187], v[116:119]
    ds_read_b64_tr_b16 v[36:37], v241 offset:40960
    ds_read_b64_tr_b16 v[38:39], v241 offset:45056
    s_waitcnt lgkmcnt(14)
    v_mfma_f32_16x16x32_bf16 v[112:115], v[48:51], v[192:195], v[112:115]
    v_mfma_f32_16x16x32_bf16 v[144:147], v[48:51], v[196:199], v[144:147]
    v_add_u32 v240, 4294901760, v240
    ds_read_b64_tr_b16 v[40:41], v240 offset:0
    ds_read_b64_tr_b16 v[42:43], v240 offset:4096
    s_waitcnt lgkmcnt(14)
    v_mfma_f32_16x16x32_bf16 v[148:151], v[52:55], v[196:199], v[148:151]
    v_mfma_f32_16x16x32_bf16 v[116:119], v[52:55], v[192:195], v[116:119]
    v_add_u32 v241, 4294901760, v241
    ds_read_b64_tr_b16 v[44:45], v241 offset:0
    ds_read_b64_tr_b16 v[46:47], v241 offset:4096
    s_waitcnt lgkmcnt(14)
    v_mfma_f32_16x16x32_bf16 v[112:115], v[16:19], v[200:203], v[112:115]
    v_mfma_f32_16x16x32_bf16 v[144:147], v[16:19], v[204:207], v[144:147]
    ds_read_b64_tr_b16 v[48:49], v240 offset:8192
    ds_read_b64_tr_b16 v[50:51], v240 offset:12288
    s_waitcnt lgkmcnt(14)
    v_mfma_f32_16x16x32_bf16 v[148:151], v[20:23], v[204:207], v[148:151]
    v_mfma_f32_16x16x32_bf16 v[116:119], v[20:23], v[200:203], v[116:119]
    ds_read_b64_tr_b16 v[52:53], v241 offset:8192
    ds_read_b64_tr_b16 v[54:55], v241 offset:12288
    s_waitcnt lgkmcnt(14)
    v_mfma_f32_16x16x32_bf16 v[124:127], v[24:27], v[208:211], 0
    v_mfma_f32_16x16x32_bf16 v[156:159], v[24:27], v[212:215], 0
    ds_read_b64_tr_b16 v[16:17], v240 offset:16384
    ds_read_b64_tr_b16 v[18:19], v240 offset:20480
    s_waitcnt lgkmcnt(14)
    v_mfma_f32_16x16x32_bf16 v[164:167], v[28:31], v[212:215], 0
    v_mfma_f32_16x16x32_bf16 v[132:135], v[28:31], v[208:211], 0
    ds_read_b64_tr_b16 v[20:21], v241 offset:16384
    ds_read_b64_tr_b16 v[22:23], v241 offset:20480
    s_waitcnt lgkmcnt(14)
    v_mfma_f32_16x16x32_bf16 v[124:127], v[32:35], v[216:219], v[124:127]
    v_mfma_f32_16x16x32_bf16 v[156:159], v[32:35], v[220:223], v[156:159]
    ds_read_b64_tr_b16 v[24:25], v240 offset:24576
    ds_read_b64_tr_b16 v[26:27], v240 offset:28672
    s_waitcnt lgkmcnt(14)
    v_mfma_f32_16x16x32_bf16 v[164:167], v[36:39], v[220:223], v[164:167]
    v_mfma_f32_16x16x32_bf16 v[132:135], v[36:39], v[216:219], v[132:135]
    ds_read_b64_tr_b16 v[28:29], v241 offset:24576
    ds_read_b64_tr_b16 v[30:31], v241 offset:28672
    s_waitcnt lgkmcnt(14)
    v_mfma_f32_16x16x32_bf16 v[124:127], v[40:43], v[56:59], v[124:127]
    s_waitcnt vmcnt(0)
    s_mov_b64 exec, 1
    buffer_store_dword v6, off, s[44:47], s95 sc1
    s_mov_b64 exec, -1
    v_mfma_f32_16x16x32_bf16 v[156:159], v[40:43], v[60:63], v[156:159]
    ds_read_b64_tr_b16 v[32:33], v240 offset:32768
    ds_read_b64_tr_b16 v[34:35], v240 offset:36864
    s_waitcnt lgkmcnt(14)
    v_mfma_f32_16x16x32_bf16 v[164:167], v[44:47], v[60:63], v[164:167]
    v_mfma_f32_16x16x32_bf16 v[132:135], v[44:47], v[56:59], v[132:135]
    ds_read_b64_tr_b16 v[36:37], v241 offset:32768
    ds_read_b64_tr_b16 v[38:39], v241 offset:36864
    s_waitcnt lgkmcnt(14)
    v_mfma_f32_16x16x32_bf16 v[124:127], v[48:51], v[64:67], v[124:127]
    v_mfma_f32_16x16x32_bf16 v[156:159], v[48:51], v[68:71], v[156:159]
    ds_read_b64_tr_b16 v[40:41], v240 offset:40960
    ds_read_b64_tr_b16 v[42:43], v240 offset:45056
    s_waitcnt lgkmcnt(14)
    v_mfma_f32_16x16x32_bf16 v[164:167], v[52:55], v[68:71], v[164:167]
    v_mfma_f32_16x16x32_bf16 v[132:135], v[52:55], v[64:67], v[132:135]
    ds_read_b64_tr_b16 v[44:45], v241 offset:40960
    ds_read_b64_tr_b16 v[46:47], v241 offset:45056
    s_waitcnt lgkmcnt(14)
    v_mfma_f32_16x16x32_bf16 v[124:127], v[16:19], v[72:75], v[124:127]
    v_mfma_f32_16x16x32_bf16 v[156:159], v[16:19], v[76:79], v[156:159]
    s_waitcnt lgkmcnt(12)
    v_mfma_f32_16x16x32_bf16 v[164:167], v[20:23], v[76:79], v[164:167]
    v_mfma_f32_16x16x32_bf16 v[132:135], v[20:23], v[72:75], v[132:135]
    s_waitcnt lgkmcnt(10)
    v_mfma_f32_16x16x32_bf16 v[124:127], v[24:27], v[80:83], v[124:127]
    v_mfma_f32_16x16x32_bf16 v[156:159], v[24:27], v[84:87], v[156:159]
    s_waitcnt lgkmcnt(8)
    v_mfma_f32_16x16x32_bf16 v[164:167], v[28:31], v[84:87], v[164:167]
    v_mfma_f32_16x16x32_bf16 v[132:135], v[28:31], v[80:83], v[132:135]
    s_waitcnt lgkmcnt(6)
    v_mfma_f32_16x16x32_bf16 v[124:127], v[32:35], v[88:91], v[124:127]
    v_mfma_f32_16x16x32_bf16 v[156:159], v[32:35], v[92:95], v[156:159]
    s_waitcnt lgkmcnt(4)
    v_mfma_f32_16x16x32_bf16 v[164:167], v[36:39], v[92:95], v[164:167]
    v_mfma_f32_16x16x32_bf16 v[132:135], v[36:39], v[88:91], v[132:135]
    s_waitcnt lgkmcnt(2)
    v_mfma_f32_16x16x32_bf16 v[124:127], v[40:43], v[96:99], v[124:127]
    v_mfma_f32_16x16x32_bf16 v[156:159], v[40:43], v[100:103], v[156:159]
    s_waitcnt lgkmcnt(0)
    v_mfma_f32_16x16x32_bf16 v[164:167], v[44:47], v[100:103], v[164:167]
    v_mfma_f32_16x16x32_bf16 v[132:135], v[44:47], v[96:99], v[132:135]
    s_mov_b32 s69, 0x40000
    s_cmp_lg_u32 s32, 0
    s_cbranch_scc1 L2_have
L2_rx:
    buffer_load_dword v7, v5, s[44:47], s68 offen sc1
    s_waitcnt vmcnt(0)
    v_cmp_ne_u32 vcc, 1, v7
    s_cbranch_vccz L2_rxok
    s_sub_u32 s69, s69, 1
    s_cbranch_scc0 L2_rx
L2_rxok:
    buffer_load_dwordx4 v[120:123], v2, s[44:47], s33 offen offset:0 sc1
    buffer_load_dwordx4 v[152:155], v2, s[44:47], s33 offen offset:1024 sc1
    buffer_load_dwordx4 v[128:131], v2, s[44:47], s34 offen offset:0 sc1
    buffer_load_dwordx4 v[160:163], v2, s[44:47], s34 offen offset:1024 sc1
    buffer_load_dwordx4 v[140:143], v2, s[44:47], s35 offen offset:0 sc1
    buffer_load_dwordx4 v[172:175], v2, s[44:47], s35 offen offset:1024 sc1
L2_have:
    v_pk_fma_f32 v[112:113], v[112:113], v[104:105], v[124:125]
    v_pk_fma_f32 v[114:115], v[114:115], v[104:105], v[126:127]
    v_pk_fma_f32 v[116:117], v[116:117], v[104:105], v[132:133]
    v_pk_fma_f32 v[118:119], v[118:119], v[104:105], v[134:135]
    v_pk_fma_f32 v[144:145], v[144:145], v[108:109], v[156:157]
    v_pk_fma_f32 v[146:147], v[146:147], v[108:109], v[158:159]
    v_pk_fma_f32 v[148:149], v[148:149], v[108:109], v[164:165]
    v_pk_fma_f32 v[150:151], v[150:151], v[108:109], v[166:167]
    v_pk_mul_f32 v[112:113], v[112:113], v[106:107]
    v_pk_mul_f32 v[114:115], v[114:115], v[106:107]
    v_pk_mul_f32 v[116:117], v[116:117], v[106:107]
    v_pk_mul_f32 v[118:119], v[118:119], v[106:107]
    v_pk_mul_f32 v[144:145], v[144:145], v[110:111]
    v_pk_mul_f32 v[146:147], v[146:147], v[110:111]
    v_pk_mul_f32 v[148:149], v[148:149], v[110:111]
    v_pk_mul_f32 v[150:151], v[150:151], v[110:111]
    s_waitcnt vmcnt(0)
    v_lshlrev_b32 v16, 16, v120
    v_and_b32 v17, 0xffff0000, v120
    v_lshlrev_b32 v18, 16, v121
    v_and_b32 v19, 0xffff0000, v121
    v_lshlrev_b32 v20, 16, v122
    v_and_b32 v21, 0xffff0000, v122
    v_lshlrev_b32 v22, 16, v123
    v_and_b32 v23, 0xffff0000, v123
    v_lshlrev_b32 v24, 16, v152
    v_and_b32 v25, 0xffff0000, v152
    v_lshlrev_b32 v26, 16, v153
    v_and_b32 v27, 0xffff0000, v153
    v_lshlrev_b32 v28, 16, v154
    v_and_b32 v29, 0xffff0000, v154
    v_lshlrev_b32 v30, 16, v155
    v_and_b32 v31, 0xffff0000, v155
    v_pk_add_f32 v[112:113], v[112:113], v[16:17]
    v_pk_add_f32 v[114:115], v[114:115], v[18:19]
    v_pk_add_f32 v[116:117], v[116:117], v[20:21]
    v_pk_add_f32 v[118:119], v[118:119], v[22:23]
    v_pk_add_f32 v[144:145], v[144:145], v[24:25]
    v_pk_add_f32 v[146:147], v[146:147], v[26:27]
    v_pk_add_f32 v[148:149], v[148:149], v[28:29]
    v_pk_add_f32 v[150:151], v[150:151], v[30:31]
    v_lshlrev_b32 v16, 16, v128
    v_and_b32 v17, 0xffff0000, v128
    v_lshlrev_b32 v18, 16, v129
    v_and_b32 v19, 0xffff0000, v129
    v_lshlrev_b32 v20, 16, v130
    v_and_b32 v21, 0xffff0000, v130
    v_lshlrev_b32 v22, 16, v131
    v_and_b32 v23, 0xffff0000, v131
    v_lshlrev_b32 v24, 16, v160
    v_and_b32 v25, 0xffff0000, v160
    v_lshlrev_b32 v26, 16, v161
    v_and_b32 v27, 0xffff0000, v161
    v_lshlrev_b32 v28, 16, v162
    v_and_b32 v29, 0xffff0000, v162
    v_lshlrev_b32 v30, 16, v163
    v_and_b32 v31, 0xffff0000, v163
    v_pk_add_f32 v[112:113], v[112:113], v[16:17]
    v_pk_add_f32 v[114:115], v[114:115], v[18:19]
    v_pk_add_f32 v[116:117], v[116:117], v[20:21]
    v_pk_add_f32 v[118:119], v[118:119], v[22:23]
    v_pk_add_f32 v[144:145], v[144:145], v[24:25]
    v_pk_add_f32 v[146:147], v[146:147], v[26:27]
    v_pk_add_f32 v[148:149], v[148:149], v[28:29]
    v_pk_add_f32 v[150:151], v[150:151], v[30:31]
    v_lshlrev_b32 v16, 16, v140
    v_and_b32 v17, 0xffff0000, v140
    v_lshlrev_b32 v18, 16, v141
    v_and_b32 v19, 0xffff0000, v141
    v_lshlrev_b32 v20, 16, v142
    v_and_b32 v21, 0xffff0000, v142
    v_lshlrev_b32 v22, 16, v143
    v_and_b32 v23, 0xffff0000, v143
    v_lshlrev_b32 v24, 16, v172
    v_and_b32 v25, 0xffff0000, v172
    v_lshlrev_b32 v26, 16, v173
    v_and_b32 v27, 0xffff0000, v173
    v_lshlrev_b32 v28, 16, v174
    v_and_b32 v29, 0xffff0000, v174
    v_lshlrev_b32 v30, 16, v175
    v_and_b32 v31, 0xffff0000, v175
    v_pk_add_f32 v[112:113], v[112:113], v[16:17]
    v_pk_add_f32 v[114:115], v[114:115], v[18:19]
    v_pk_add_f32 v[116:117], v[116:117], v[20:21]
    v_pk_add_f32 v[118:119], v[118:119], v[22:23]
    v_pk_add_f32 v[144:145], v[144:145], v[24:25]
    v_pk_add_f32 v[146:147], v[146:147], v[26:27]
    v_pk_add_f32 v[148:149], v[148:149], v[28:29]
    v_pk_add_f32 v[150:151], v[150:151], v[30:31]
    v_cvt_pk_bf16_f32 v48, v112, v113
    v_cvt_pk_bf16_f32 v49, v114, v115
    v_cvt_pk_bf16_f32 v50, v116, v117
    v_cvt_pk_bf16_f32 v51, v118, v119
    v_cvt_pk_bf16_f32 v52, v144, v145
    v_permlane16_swap_b32 v48, v50
    v_cvt_pk_bf16_f32 v53, v146, v147
    v_permlane16_swap_b32 v49, v51
    v_cvt_pk_bf16_f32 v54, v148, v149
    v_cvt_pk_bf16_f32 v55, v150, v151
    buffer_store_dwordx4 v[48:51], v4, s[40:43], s14 offen
    v_permlane16_swap_b32 v52, v54
    v_permlane16_swap_b32 v53, v55
    buffer_store_dwordx4 v[52:55], v4, s[40:43], s15 offen
L_end:
L_last:
    s_endpgm
.section .rodata,"a"
.p2align 6
.amdhsa_kernel gated_mix__linear_kernel_hedgehog__glu_gated_glu__prompt_kernel
  .amdhsa_next_free_vgpr 256
  .amdhsa_next_free_sgpr 102
  .amdhsa_accum_offset 256
  .amdhsa_group_segment_fixed_size 0
  .amdhsa_kernarg_size 96
  .amdhsa_user_sgpr_count 2
  .amdhsa_user_sgpr_kernarg_segment_ptr 1
  .amdhsa_system_sgpr_workgroup_id_x 1
.end_amdhsa_kernel
.text
```
